```python
import torch

def _softmax(x, axis=-1):
    return torch.softmax(x, dim=axis)
def _gelu(x):
    return torch.nn.functional.gelu(x, approximate="tanh")
def _silu(x):
    return torch.nn.functional.silu(x)
def _sigmoid(x):
    return torch.sigmoid(x)
def _layernorm(x, axis=-1, eps=1e-5):
    m = x.mean(dim=axis, keepdim=True)
    v = x.var(dim=axis, keepdim=True, unbiased=False)
    return (x - m) / torch.sqrt(v + eps)
def _scatter_add(tgt, idx, src, axis=0):
    return tgt.clone().index_add_(axis, idx, src)
def _segment_sum(src, seg, n):
    out = torch.zeros((n,) + src.shape[1:], dtype=src.dtype)
    return out.index_add_(0, seg, src)
def _pad(x, pw):
    flat = tuple(v for pair in reversed(pw) for v in pair)
    return torch.nn.functional.pad(x, flat)

kernel_name = 'gated_mix__ssm_conv_s4__dense_activation_silu__prompt'

def setup_inputs():

    _w = (lambda a: (lambda t: t.to(torch.bfloat16) if t.is_floating_point() else t)(torch.as_tensor(a)))
    def _A_setup():
        B, L, D, N = 1, 2048, 640, 192
        A_re = -(lambda _x: torch.exp(torch.as_tensor(_x)))((lambda *s: torch.randn(*s, dtype=torch.bfloat16) * 6.4)(D, N))
        A_im = torch.pi * (lambda *s: torch.randn(*s, dtype=torch.bfloat16) * 0.05)(D, N)
        B_re = (lambda *s: torch.randn(*s, dtype=torch.bfloat16) * 0.2)(D, N)
        B_im = (lambda *s: torch.randn(*s, dtype=torch.bfloat16) * 0.2)(D, N)
        C_re = (lambda *s: torch.randn(*s, dtype=torch.bfloat16) * 0.2)(D, N)
        C_im = (lambda *s: torch.randn(*s, dtype=torch.bfloat16) * 0.2)(D, N)
        log_dt = (lambda *s: torch.randn(*s, dtype=torch.bfloat16) * 0.05)(D) * 0.5 - 4.0
        Dskip = (lambda *s: torch.randn(*s, dtype=torch.bfloat16) * 0.05)(D)
        return {
            "u": _w((lambda *s: torch.randn(*s, dtype=torch.bfloat16) * 0.05)(B, L, D)),
            "A_re": _w(A_re),
            "A_im": _w(A_im),
            "B_re": _w(B_re),
            "B_im": _w(B_im),
            "C_re": _w(C_re),
            "C_im": _w(C_im),
            "log_dt": _w(log_dt),
            "Dskip": _w(Dskip),
        }
    _A_in = _A_setup()

    def _B_setup():
        B, S, D, F = 1, 2048, 640, 1536
        return {
            "x": _w((lambda *s: torch.randn(*s, dtype=torch.bfloat16) * 0.05)(B, S, D)),
            "w1": _w((lambda *s: torch.randn(*s, dtype=torch.bfloat16) * 6.4)(D, F) * (D ** -0.5)),
            "w2": _w((lambda *s: torch.randn(*s, dtype=torch.bfloat16) * 0.2)(F, D) * (F ** -0.5)),
        }
    _B_in = _B_setup()

    return {
        "A_u": _A_in["u"],
        "A_A_re": _A_in["A_re"],
        "A_A_im": _A_in["A_im"],
        "A_B_re": _A_in["B_re"],
        "A_B_im": _A_in["B_im"],
        "A_C_re": _A_in["C_re"],
        "A_C_im": _A_in["C_im"],
        "A_log_dt": _A_in["log_dt"],
        "A_Dskip": _A_in["Dskip"],
        "B_x": _B_in["x"],
        "B_w1": _B_in["w1"],
        "B_w2": _B_in["w2"],
        "gate_w": _w((lambda *s: torch.randn(*s, dtype=torch.bfloat16) * 0.05)(640) * 16.0),
    }

def reference(A_u, A_A_re, A_A_im, A_B_re, A_B_im, A_C_re, A_C_im, A_log_dt, A_Dskip, B_x, B_w1, B_w2, gate_w):
    def _A_ref(u, A_re, A_im, B_re, B_im, C_re, C_im, log_dt, Dskip):
        Bsz, L, D = u.shape
        dt = torch.exp(log_dt)[:, None]
        A = A_re + 1j * A_im
        Bc = B_re + 1j * B_im
        Cc = C_re + 1j * C_im
        logdA = dt * A
        dB = dt * Bc
        l = (lambda x, dt: x.to(dt))(torch.arange(L), A_re.dtype)
        P = torch.exp(logdA[:, :, None] * l[None, None, :])
        K = torch.einsum("dn,dnl,dn->dl", Cc, P, dB).real
        L2 = 2 * L
        Kp = _pad(K, ((0, 0), (0, L)))
        up = (lambda x, *d: x.permute(*d))(u, 0, 2, 1)
        up = _pad(up, ((0, 0), (0, 0), (0, L)))
        Kf = (lambda x, axes=(-2,-1): torch.fft.rfft2(x.float(), dim=axes))(Kp[:, None, :], axes=(-2, -1))
        Uf = (lambda x, axes=(-2,-1): torch.fft.rfft2(x.float(), dim=axes))(up[:, :, None, :], axes=(-2, -1))
        Yf = Uf * Kf[None, :, :, :]
        y = (lambda x, s, axes=(-2,-1): torch.fft.irfft2(x, s=s, dim=axes).to(torch.bfloat16))(Yf, (1, L2), axes=(-2, -1))[:, :, 0, :L]
        y = (lambda x, *d: x.permute(*d))(y, 0, 2, 1) + u * Dskip[None, None, :]
        return y

    def _B_ref(x, w1, w2):
        h = torch.einsum("bsd,df->bsf", x, w1)
        h = _silu(h)
        out = torch.einsum("bsf,fd->bsd", h, w2)
        return out

    x = A_u
    g = _sigmoid((x * gate_w).sum(-1, keepdims=True))
    a = _A_ref(x, A_A_re, A_A_im, A_B_re, A_B_im, A_C_re, A_C_im, A_log_dt, A_Dskip)
    b = _B_ref(x, B_w1, B_w2)
    return g * a + (1 - g) * b
```

```asm
; @launch grid=(512,1,1) block=(256,1,1) lds=81920
.amdgcn_target "amdgcn-amd-amdhsa--gfx950"
.text
.globl gated_mix__ssm_conv_s4__dense_activation_silu__prompt_kernel
.p2align 8
.type gated_mix__ssm_conv_s4__dense_activation_silu__prompt_kernel,@function
gated_mix__ssm_conv_s4__dense_activation_silu__prompt_kernel:
    s_load_dwordx16 s[16:31], s[0:1], 0
    s_load_dwordx16 s[32:47], s[0:1], 64
    s_memrealtime s[10:11]
    v_lshrrev_b32 v1, 6, v0
    v_and_b32 v0, 63, v0
    v_readfirstlane_b32 s3, v1
    s_cmp_ge_u32 s2, 512
    s_cbranch_scc1 L_end
    s_and_b32 s4, s2, 255
    s_bfe_u32 s66, s2, 0x20001
    s_bfe_u32 s67, s2, 0x30003
    s_lshl3_add_u32 s5, s66, s67
    s_and_b32 s66, s2, 1
    s_bfe_u32 s67, s2, 0x20006
    s_lshl2_add_u32 s6, s66, s67
    s_mov_b32 s50, 0x1000000
    s_mov_b32 s51, 0x20000
    s_mov_b32 s54, 0x280000
    s_mov_b32 s55, 0x20000
    s_cmp_lg_u32 s3, 0
    s_cbranch_scc1 L_noipf
    s_getpc_b64 s[64:65]
    s_lshr_b32 s66, s2, 3
    s_mul_i32 s66, s66, 512
    v_lshlrev_b32 v1, 7, v0
    v_add_u32 v1, s66, v1
    s_mov_b64 exec, 15
    global_load_dword v255, v1, s[64:65]
    s_mov_b64 exec, -1
L_noipf:
    s_cmp_ge_u32 s2, 256
    s_cbranch_scc1 L_gemm
    s_cmp_eq_u32 s3, 3
    s_cbranch_scc1 L_misc
L_chanh:
    s_mul_i32 s64, s4, 3
    s_lshl_b32 s65, s4, 1
    s_add_u32 s65, s65, 128
    s_cmp_lt_u32 s4, 128
    s_cselect_b32 s64, s64, s65
    s_cselect_b32 s65, 3, 2
    s_cmp_ge_u32 s3, s65
    s_cbranch_scc1 L_idle
    s_add_u32 s12, s64, s3
    s_mul_i32 s13, s3, 17664
    v_mov_b32 v234, 0
    v_mov_b32 v237, 0
    v_mov_b32 v240, 0
    v_mov_b32 v243, 0
    v_mov_b32 v246, 0
    v_mov_b32 v249, 0
    s_mul_i32 s64, s12, 384
    v_lshlrev_b32 v1, 1, v0
    v_add_u32 v1, s64, v1
    v_lshl_add_u32 v2, v0, 2, s64
    s_lshr_b32 s64, s12, 1
    s_lshl_b32 s64, s64, 2
    s_waitcnt lgkmcnt(0)
    global_load_dword v233, v2, s[18:19]
    global_load_dword v236, v2, s[20:21]
    global_load_dword v239, v2, s[22:23]
    global_load_dword v242, v2, s[24:25]
    global_load_dword v245, v2, s[26:27]
    global_load_dword v248, v2, s[28:29]
    s_load_dword s65, s[30:31], s64
    s_load_dword s66, s[32:33], s64
    global_load_short_d16_hi v234, v1, s[18:19] offset:256
    global_load_short_d16_hi v237, v1, s[20:21] offset:256
    global_load_short_d16_hi v240, v1, s[22:23] offset:256
    global_load_short_d16_hi v243, v1, s[24:25] offset:256
    global_load_short_d16_hi v246, v1, s[26:27] offset:256
    global_load_short_d16_hi v249, v1, s[28:29] offset:256
    s_branch L_chan_main
L_misc:
    v_add_u32 v1, 0, v0
    v_mul_u32_u24 v2, 205, v1
    v_lshrrev_b32 v2, 11, v2
    v_mul_u32_u24 v3, 1120, v2
    v_lshl_add_u32 v10, v1, 4, v3
    v_add_u32 v1, 64, v0
    v_mul_u32_u24 v2, 205, v1
    v_lshrrev_b32 v2, 11, v2
    v_mul_u32_u24 v3, 1120, v2
    v_lshl_add_u32 v11, v1, 4, v3
    v_add_u32 v1, 128, v0
    v_mul_u32_u24 v2, 205, v1
    v_lshrrev_b32 v2, 11, v2
    v_mul_u32_u24 v3, 1120, v2
    v_lshl_add_u32 v12, v1, 4, v3
    v_add_u32 v1, 192, v0
    v_mul_u32_u24 v2, 205, v1
    v_lshrrev_b32 v2, 11, v2
    v_mul_u32_u24 v3, 1120, v2
    v_lshl_add_u32 v13, v1, 4, v3
    v_add_u32 v1, 256, v0
    v_mul_u32_u24 v2, 205, v1
    v_lshrrev_b32 v2, 11, v2
    v_mul_u32_u24 v3, 1120, v2
    v_lshl_add_u32 v14, v1, 4, v3
    s_mul_i32 s64, s5, 81920
    s_mul_i32 s65, s6, 160
    s_add_u32 s64, s64, s65
    s_add_u32 s65, s64, 40960
    s_waitcnt lgkmcnt(0)
    s_mov_b64 s[52:53], s[16:17]
    s_mov_b32 m0, 52992
    s_nop 0
    buffer_load_dwordx4 v10, s[52:55], s64 offen lds
    s_mov_b32 m0, 54016
    s_nop 0
    buffer_load_dwordx4 v11, s[52:55], s64 offen lds
    s_mov_b32 m0, 55040
    s_nop 0
    buffer_load_dwordx4 v12, s[52:55], s64 offen lds
    s_mov_b32 m0, 56064
    s_nop 0
    buffer_load_dwordx4 v13, s[52:55], s64 offen lds
    s_mov_b32 m0, 57088
    s_nop 0
    buffer_load_dwordx4 v14, s[52:55], s64 offen lds
    s_mov_b32 m0, 58112
    s_nop 0
    buffer_load_dwordx4 v10, s[52:55], s65 offen lds
    s_mov_b32 m0, 59136
    s_nop 0
    buffer_load_dwordx4 v11, s[52:55], s65 offen lds
    s_mov_b32 m0, 60160
    s_nop 0
    buffer_load_dwordx4 v12, s[52:55], s65 offen lds
    s_mov_b32 m0, 61184
    s_nop 0
    buffer_load_dwordx4 v13, s[52:55], s65 offen lds
    s_mov_b32 m0, 62208
    s_nop 0
    buffer_load_dwordx4 v14, s[52:55], s65 offen lds
    s_setprio 3
    s_mov_b64 s[48:49], s[46:47]
    s_mov_b64 s[56:57], s[38:39]
    s_mov_b32 s58, 0x1e0000
    s_mov_b32 s59, 0x20000
    s_sub_u32 s66, s4, 240
    s_mul_i32 s66, s66, 15
    s_cmp_lt_u32 s4, 240
    s_cselect_b32 s66, s4, s66
    s_mul_i32 s67, s66, 205
    s_lshr_b32 s67, s67, 10
    s_mul_i32 s68, s67, 5
    s_sub_u32 s68, s66, s68
    s_mul_i32 s69, s67, 40960
    s_lshl_b32 s70, s68, 8
    s_add_u32 s69, s69, s70
    v_lshrrev_b32 v1, 4, v0
    v_and_b32 v2, 15, v0
    v_mul_u32_u24 v1, 1280, v1
    v_lshl_add_u32 v15, v2, 4, v1
    s_mov_b32 m0, 63232
    s_nop 0
    buffer_load_dwordx4 v15, s[56:59], s69 offen lds
    s_add_u32 s69, s69, 5120
    s_mov_b32 m0, 64256
    s_nop 0
    buffer_load_dwordx4 v15, s[56:59], s69 offen lds
    s_add_u32 s69, s69, 5120
    s_mov_b32 m0, 65280
    s_nop 0
    buffer_load_dwordx4 v15, s[56:59], s69 offen lds
    s_add_u32 s69, s69, 5120
    s_mov_b32 m0, 66304
    s_nop 0
    buffer_load_dwordx4 v15, s[56:59], s69 offen lds
    s_add_u32 s69, s69, 5120
    s_mov_b32 m0, 67328
    s_nop 0
    buffer_load_dwordx4 v15, s[56:59], s69 offen lds
    s_add_u32 s69, s69, 5120
    s_mov_b32 m0, 68352
    s_nop 0
    buffer_load_dwordx4 v15, s[56:59], s69 offen lds
    s_add_u32 s69, s69, 5120
    s_mov_b32 m0, 69376
    s_nop 0
    buffer_load_dwordx4 v15, s[56:59], s69 offen lds
    s_add_u32 s69, s69, 5120
    s_mov_b32 m0, 70400
    s_nop 0
    buffer_load_dwordx4 v15, s[56:59], s69 offen lds
    s_add_u32 s69, s69, 5120
    s_branch L_misc_main
L_idle:
    s_cmp_lg_u32 s2, 128
    s_cbranch_scc1 L_end
    s_cmp_lg_u32 s3, 2
    s_cbranch_scc1 L_end
    v_lshlrev_b32 v2, 6, v0
    s_waitcnt lgkmcnt(0)
    s_or_b32 s10, s10, 1
    v_mov_b32 v1, s10
    s_mov_b64 exec, 15
    global_store_dword v2, v1, s[44:45] sc1
    s_endpgm
L_gemm:
    v_lshrrev_b32 v30, 4, v0
    v_and_b32 v31, 15, v0
    v_and_b32 v27, 2, v30
    v_add_u32 v27, v27, v30
    s_and_b32 s64, s3, 2
    v_xor_b32 v27, v31, v27
    v_xor_b32 v27, s64, v27
    v_lshlrev_b32 v27, 4, v27
    s_mul_i32 s64, s3, 20480
    v_mul_u32_u24 v26, 1280, v30
    v_add_u32 v26, s64, v26
    v_add_u32 v80, v26, v27
    v_xor_b32 v28, 128, v27
    v_add_u32 v28, 4096, v28
    v_add_u32 v81, v26, v28
    v_add_u32 v82, 8192, v80
    v_add_u32 v83, 8192, v81
    s_mul_i32 s68, s5, 81920
    s_lshl_b32 s9, s3, 12
    s_waitcnt lgkmcnt(0)
    s_mov_b64 s[52:53], s[16:17]
    s_add_u32 m0, s9, 0
    s_nop 0
    buffer_load_dwordx4 v80, s[52:55], s68 offen offset:0 lds
    buffer_load_dwordx4 v81, s[52:55], s68 offen offset:1024 lds
    buffer_load_dwordx4 v82, s[52:55], s68 offen offset:2048 lds
    buffer_load_dwordx4 v83, s[52:55], s68 offen offset:3072 lds
    s_mov_b64 s[56:57], s[36:37]
    s_mov_b32 s58, 0x1e0000
    s_mov_b32 s59, 0x20000
    v_lshrrev_b32 v26, 3, v0
    s_lshl_b32 s65, s3, 5
    v_add_u32 v26, s65, v26
    v_mul_u32_u24 v26, 3072, v26
    v_and_b32 v27, 7, v0
    v_and_b32 v28, 1, v30
    v_lshlrev_b32 v28, 2, v28
    v_xor_b32 v27, v27, v28
    v_lshl_add_u32 v17, v27, 4, v26
    v_add_u32 v18, 23552, v17
    v_add_u32 v19, 47104, v17
    v_add_u32 v20, 70656, v17
    s_mul_i32 s73, s6, 384
    s_branch L_gemm_main
L_chan_main:
    s_mov_b64 s[48:49], s[46:47]
    v_and_b32 v6, 31, v0
    v_lshrrev_b32 v7, 5, v0
    v_lshlrev_b32 v7, 3, v7
    v_sub_u32 v6, v6, v7
    v_and_b32 v7, 1, v0
    v_lshlrev_b32 v7, 4, v7
    v_mov_b32 v8, 0x3f80
    v_lshlrev_b32 v7, v7, v8
    v_lshrrev_b32 v6, 1, v6
    v_cmp_eq_u32 vcc, 0, v6
    s_nop 1
    v_cndmask_b32 v208, 0, v7, vcc
    v_cmp_eq_u32 vcc, 1, v6
    s_nop 1
    v_cndmask_b32 v209, 0, v7, vcc
    v_cmp_eq_u32 vcc, 2, v6
    s_nop 1
    v_cndmask_b32 v210, 0, v7, vcc
    v_cmp_eq_u32 vcc, 3, v6
    s_nop 1
    v_cndmask_b32 v211, 0, v7, vcc
    v_cmp_eq_u32 vcc, 8, v6
    s_nop 1
    v_cndmask_b32 v212, 0, v7, vcc
    v_cmp_eq_u32 vcc, 9, v6
    s_nop 1
    v_cndmask_b32 v213, 0, v7, vcc
    v_cmp_eq_u32 vcc, 10, v6
    s_nop 1
    v_cndmask_b32 v214, 0, v7, vcc
    v_cmp_eq_u32 vcc, 11, v6
    s_nop 1
    v_cndmask_b32 v215, 0, v7, vcc
    v_mov_b32 v16, 0
    v_mov_b32 v17, 0
    v_mov_b32 v18, 0
    v_mov_b32 v19, 0
    v_mov_b32 v20, 0
    v_mov_b32 v21, 0
    v_mov_b32 v22, 0
    v_mov_b32 v23, 0
    v_mov_b32 v24, 0
    v_mov_b32 v25, 0
    v_mov_b32 v26, 0
    v_mov_b32 v27, 0
    v_mov_b32 v28, 0
    v_mov_b32 v29, 0
    v_mov_b32 v30, 0
    v_mov_b32 v31, 0
    s_and_b32 s64, s12, 1
    s_lshl_b32 s64, s64, 4
    s_waitcnt lgkmcnt(0)
    s_lshr_b32 s65, s65, s64
    s_lshl_b32 s65, s65, 16
    s_lshr_b32 s66, s66, s64
    s_lshl_b32 s14, s66, 16
    v_mov_b32 v6, s65
    v_mul_f32 v6, 0x3fb8aa3b, v6
    v_exp_f32 v6, v6
    s_nop 0
    v_cvt_pk_bf16_f32 v6, v6, v6
    v_lshlrev_b32 v4, 16, v6
    s_waitcnt vmcnt(6)
    v_lshlrev_b32 v232, 16, v233
    v_and_b32 v233, 0xffff0000, v233
    v_lshlrev_b32 v235, 16, v236
    v_and_b32 v236, 0xffff0000, v236
    v_lshlrev_b32 v238, 16, v239
    v_and_b32 v239, 0xffff0000, v239
    v_lshlrev_b32 v241, 16, v242
    v_and_b32 v242, 0xffff0000, v242
    v_lshlrev_b32 v244, 16, v245
    v_and_b32 v245, 0xffff0000, v245
    v_lshlrev_b32 v247, 16, v248
    v_and_b32 v248, 0xffff0000, v248
    v_mul_f32 v216, v4, v232
    v_mul_f32 v217, v4, v235
    v_mul_f32 v216, 0x3fb8aa3b, v216
    v_mul_f32 v217, 0x3e22f983, v217
    v_rndne_f32 v194, v217
    v_mul_f32 v192, v4, v238
    v_mul_f32 v193, v4, v241
    v_sub_f32 v217, v217, v194
    v_mul_f32 v230, v244, v192
    v_mul_f32 v231, v244, v193
    v_fma_f32 v230, -v247, v193, v230
    v_fmac_f32 v231, v247, v192
    v_mul_f32 v196, 0x41000000, v216
    v_mul_f32 v197, 0x41000000, v217
    v_exp_f32 v198, v196
    v_cos_f32 v224, v197
    v_sin_f32 v225, v197
    v_exp_f32 v202, v216
    v_cos_f32 v218, v217
    v_sin_f32 v219, v217
    v_mul_f32 v204, 0x43800000, v216
    v_mul_f32 v205, 0x43800000, v217
    v_exp_f32 v206, v204
    v_cos_f32 v226, v205
    v_sin_f32 v227, v205
    v_mul_f32 v224, v224, v198
    v_mul_f32 v225, v225, v198
    v_mul_f32 v218, v218, v202
    v_mul_f32 v219, v219, v202
    v_mul_f32 v226, v226, v206
    v_mul_f32 v227, v227, v206
    s_mov_b32 s73, 0
.p2align 3
L_kbody:
    v_pk_mul_f32 v[228:229], v[224:225], v[224:225] op_sel:[0,0] op_sel_hi:[0,1]
    v_pk_fma_f32 v[228:229], v[224:225], v[224:225], v[228:229] op_sel:[1,1,0] op_sel_hi:[1,0,1] neg_lo:[1,0,0]
    v_pk_mul_f32 v[134:135], v[224:225], v[228:229] op_sel:[0,0] op_sel_hi:[0,1]
    v_pk_fma_f32 v[134:135], v[224:225], v[228:229], v[134:135] op_sel:[1,1,0] op_sel_hi:[1,0,1] neg_lo:[1,0,0]
    v_pk_mul_f32 v[136:137], v[228:229], v[228:229] op_sel:[0,0] op_sel_hi:[0,1]
    v_pk_fma_f32 v[136:137], v[228:229], v[228:229], v[136:137] op_sel:[1,1,0] op_sel_hi:[1,0,1] neg_lo:[1,0,0]
    v_pk_mul_f32 v[138:139], v[134:135], v[228:229] op_sel:[0,0] op_sel_hi:[0,1]
    v_pk_fma_f32 v[138:139], v[134:135], v[228:229], v[138:139] op_sel:[1,1,0] op_sel_hi:[1,0,1] neg_lo:[1,0,0]
    v_pk_mul_f32 v[140:141], v[136:137], v[228:229] op_sel:[0,0] op_sel_hi:[0,1]
    v_pk_fma_f32 v[140:141], v[136:137], v[228:229], v[140:141] op_sel:[1,1,0] op_sel_hi:[1,0,1] neg_lo:[1,0,0]
    v_pk_mul_f32 v[142:143], v[138:139], v[228:229] op_sel:[0,0] op_sel_hi:[0,1]
    v_pk_fma_f32 v[142:143], v[138:139], v[228:229], v[142:143] op_sel:[1,1,0] op_sel_hi:[1,0,1] neg_lo:[1,0,0]
    v_pk_mul_f32 v[144:145], v[140:141], v[228:229] op_sel:[0,0] op_sel_hi:[0,1]
    v_pk_fma_f32 v[144:145], v[140:141], v[228:229], v[144:145] op_sel:[1,1,0] op_sel_hi:[1,0,1] neg_lo:[1,0,0]
    v_pk_mul_f32 v[146:147], v[142:143], v[228:229] op_sel:[0,0] op_sel_hi:[0,1]
    v_pk_fma_f32 v[146:147], v[142:143], v[228:229], v[146:147] op_sel:[1,1,0] op_sel_hi:[1,0,1] neg_lo:[1,0,0]
    v_pk_mul_f32 v[148:149], v[144:145], v[228:229] op_sel:[0,0] op_sel_hi:[0,1]
    v_pk_fma_f32 v[148:149], v[144:145], v[228:229], v[148:149] op_sel:[1,1,0] op_sel_hi:[1,0,1] neg_lo:[1,0,0]
    v_pk_mul_f32 v[150:151], v[146:147], v[228:229] op_sel:[0,0] op_sel_hi:[0,1]
    v_pk_fma_f32 v[150:151], v[146:147], v[228:229], v[150:151] op_sel:[1,1,0] op_sel_hi:[1,0,1] neg_lo:[1,0,0]
    v_pk_mul_f32 v[152:153], v[148:149], v[228:229] op_sel:[0,0] op_sel_hi:[0,1]
    v_pk_fma_f32 v[152:153], v[148:149], v[228:229], v[152:153] op_sel:[1,1,0] op_sel_hi:[1,0,1] neg_lo:[1,0,0]
    v_pk_mul_f32 v[154:155], v[150:151], v[228:229] op_sel:[0,0] op_sel_hi:[0,1]
    v_pk_fma_f32 v[154:155], v[150:151], v[228:229], v[154:155] op_sel:[1,1,0] op_sel_hi:[1,0,1] neg_lo:[1,0,0]
    v_pk_mul_f32 v[156:157], v[152:153], v[228:229] op_sel:[0,0] op_sel_hi:[0,1]
    v_pk_fma_f32 v[156:157], v[152:153], v[228:229], v[156:157] op_sel:[1,1,0] op_sel_hi:[1,0,1] neg_lo:[1,0,0]
    v_pk_mul_f32 v[158:159], v[154:155], v[228:229] op_sel:[0,0] op_sel_hi:[0,1]
    v_pk_fma_f32 v[158:159], v[154:155], v[228:229], v[158:159] op_sel:[1,1,0] op_sel_hi:[1,0,1] neg_lo:[1,0,0]
    v_pk_mul_f32 v[160:161], v[156:157], v[228:229] op_sel:[0,0] op_sel_hi:[0,1]
    v_pk_fma_f32 v[160:161], v[156:157], v[228:229], v[160:161] op_sel:[1,1,0] op_sel_hi:[1,0,1] neg_lo:[1,0,0]
    v_pk_mul_f32 v[162:163], v[158:159], v[228:229] op_sel:[0,0] op_sel_hi:[0,1]
    v_pk_fma_f32 v[162:163], v[158:159], v[228:229], v[162:163] op_sel:[1,1,0] op_sel_hi:[1,0,1] neg_lo:[1,0,0]
    v_pk_mul_f32 v[164:165], v[160:161], v[228:229] op_sel:[0,0] op_sel_hi:[0,1]
    v_pk_fma_f32 v[164:165], v[160:161], v[228:229], v[164:165] op_sel:[1,1,0] op_sel_hi:[1,0,1] neg_lo:[1,0,0]
    v_pk_mul_f32 v[166:167], v[162:163], v[228:229] op_sel:[0,0] op_sel_hi:[0,1]
    v_pk_fma_f32 v[166:167], v[162:163], v[228:229], v[166:167] op_sel:[1,1,0] op_sel_hi:[1,0,1] neg_lo:[1,0,0]
    v_pk_mul_f32 v[168:169], v[164:165], v[228:229] op_sel:[0,0] op_sel_hi:[0,1]
    v_pk_fma_f32 v[168:169], v[164:165], v[228:229], v[168:169] op_sel:[1,1,0] op_sel_hi:[1,0,1] neg_lo:[1,0,0]
    v_pk_mul_f32 v[170:171], v[166:167], v[228:229] op_sel:[0,0] op_sel_hi:[0,1]
    v_pk_fma_f32 v[170:171], v[166:167], v[228:229], v[170:171] op_sel:[1,1,0] op_sel_hi:[1,0,1] neg_lo:[1,0,0]
    v_pk_mul_f32 v[172:173], v[168:169], v[228:229] op_sel:[0,0] op_sel_hi:[0,1]
    v_pk_fma_f32 v[172:173], v[168:169], v[228:229], v[172:173] op_sel:[1,1,0] op_sel_hi:[1,0,1] neg_lo:[1,0,0]
    v_pk_mul_f32 v[174:175], v[170:171], v[228:229] op_sel:[0,0] op_sel_hi:[0,1]
    v_pk_fma_f32 v[174:175], v[170:171], v[228:229], v[174:175] op_sel:[1,1,0] op_sel_hi:[1,0,1] neg_lo:[1,0,0]
    v_pk_mul_f32 v[176:177], v[172:173], v[228:229] op_sel:[0,0] op_sel_hi:[0,1]
    v_pk_fma_f32 v[176:177], v[172:173], v[228:229], v[176:177] op_sel:[1,1,0] op_sel_hi:[1,0,1] neg_lo:[1,0,0]
    v_pk_mul_f32 v[178:179], v[174:175], v[228:229] op_sel:[0,0] op_sel_hi:[0,1]
    v_pk_fma_f32 v[178:179], v[174:175], v[228:229], v[178:179] op_sel:[1,1,0] op_sel_hi:[1,0,1] neg_lo:[1,0,0]
    v_pk_mul_f32 v[180:181], v[176:177], v[228:229] op_sel:[0,0] op_sel_hi:[0,1]
    v_pk_fma_f32 v[180:181], v[176:177], v[228:229], v[180:181] op_sel:[1,1,0] op_sel_hi:[1,0,1] neg_lo:[1,0,0]
    v_pk_mul_f32 v[182:183], v[178:179], v[228:229] op_sel:[0,0] op_sel_hi:[0,1]
    v_pk_fma_f32 v[182:183], v[178:179], v[228:229], v[182:183] op_sel:[1,1,0] op_sel_hi:[1,0,1] neg_lo:[1,0,0]
    v_pk_mul_f32 v[184:185], v[180:181], v[228:229] op_sel:[0,0] op_sel_hi:[0,1]
    v_pk_fma_f32 v[184:185], v[180:181], v[228:229], v[184:185] op_sel:[1,1,0] op_sel_hi:[1,0,1] neg_lo:[1,0,0]
    v_pk_mul_f32 v[186:187], v[182:183], v[228:229] op_sel:[0,0] op_sel_hi:[0,1]
    v_pk_fma_f32 v[186:187], v[182:183], v[228:229], v[186:187] op_sel:[1,1,0] op_sel_hi:[1,0,1] neg_lo:[1,0,0]
    v_pk_mul_f32 v[188:189], v[184:185], v[228:229] op_sel:[0,0] op_sel_hi:[0,1]
    v_pk_fma_f32 v[188:189], v[184:185], v[228:229], v[188:189] op_sel:[1,1,0] op_sel_hi:[1,0,1] neg_lo:[1,0,0]
    v_pk_mul_f32 v[190:191], v[186:187], v[228:229] op_sel:[0,0] op_sel_hi:[0,1]
    v_pk_fma_f32 v[190:191], v[186:187], v[228:229], v[190:191] op_sel:[1,1,0] op_sel_hi:[1,0,1] neg_lo:[1,0,0]
    v_cvt_pk_bf16_f32 v192, 1.0, v224
    v_cvt_pk_bf16_f32 v193, v228, v134
    v_cvt_pk_bf16_f32 v194, v136, v138
    v_cvt_pk_bf16_f32 v195, v140, v142
    v_cvt_pk_bf16_f32 v196, v144, v146
    v_cvt_pk_bf16_f32 v197, v148, v150
    v_cvt_pk_bf16_f32 v198, v152, v154
    v_cvt_pk_bf16_f32 v199, v156, v158
    v_cvt_pk_bf16_f32 v200, v160, v162
    v_cvt_pk_bf16_f32 v201, v164, v166
    v_cvt_pk_bf16_f32 v202, v168, v170
    v_cvt_pk_bf16_f32 v203, v172, v174
    v_cvt_pk_bf16_f32 v204, v176, v178
    v_cvt_pk_bf16_f32 v205, v180, v182
    v_cvt_pk_bf16_f32 v206, v184, v186
    v_cvt_pk_bf16_f32 v207, v188, v190
    v_permlane32_swap_b32 v192, v196
    v_permlane32_swap_b32 v193, v197
    v_permlane32_swap_b32 v194, v198
    v_permlane32_swap_b32 v195, v199
    v_permlane32_swap_b32 v200, v204
    v_permlane32_swap_b32 v201, v205
    v_permlane32_swap_b32 v202, v206
    v_permlane32_swap_b32 v203, v207
    v_mfma_f32_32x32x16_bf16 v[64:79], v[192:195], v[208:211], 0
    v_cvt_pk_bf16_f32 v128, 0, -v225
    v_cvt_pk_bf16_f32 v129, -v229, -v135
    v_cvt_pk_bf16_f32 v130, -v137, -v139
    v_cvt_pk_bf16_f32 v131, -v141, -v143
    v_cvt_pk_bf16_f32 v144, -v145, -v147
    v_cvt_pk_bf16_f32 v145, -v149, -v151
    v_mfma_f32_32x32x16_bf16 v[64:79], v[200:203], v[212:215], v[64:79]
    v_cvt_pk_bf16_f32 v146, -v153, -v155
    v_cvt_pk_bf16_f32 v147, -v157, -v159
    v_cvt_pk_bf16_f32 v160, -v161, -v163
    v_cvt_pk_bf16_f32 v161, -v165, -v167
    v_cvt_pk_bf16_f32 v162, -v169, -v171
    v_cvt_pk_bf16_f32 v163, -v173, -v175
    v_mfma_f32_32x32x16_bf16 v[80:95], v[196:199], v[208:211], 0
    v_cvt_pk_bf16_f32 v176, -v177, -v179
    v_cvt_pk_bf16_f32 v177, -v181, -v183
    v_cvt_pk_bf16_f32 v178, -v185, -v187
    v_cvt_pk_bf16_f32 v179, -v189, -v191
    v_permlane32_swap_b32 v128, v144
    v_permlane32_swap_b32 v129, v145
    v_mfma_f32_32x32x16_bf16 v[80:95], v[204:207], v[212:215], v[80:95]
    v_permlane32_swap_b32 v130, v146
    v_permlane32_swap_b32 v131, v147
    v_permlane32_swap_b32 v160, v176
    v_permlane32_swap_b32 v161, v177
    v_permlane32_swap_b32 v162, v178
    v_permlane32_swap_b32 v163, v179
    v_mfma_f32_32x32x16_bf16 v[96:111], v[128:131], v[208:211], 0
    v_cvt_pk_bf16_f32 v32, v64, v65
    v_cvt_pk_bf16_f32 v33, v66, v67
    v_cvt_pk_bf16_f32 v34, v68, v69
    v_cvt_pk_bf16_f32 v35, v70, v71
    v_mfma_f32_32x32x16_bf16 v[96:111], v[160:163], v[212:215], v[96:111]
    v_cvt_pk_bf16_f32 v36, v72, v73
    v_cvt_pk_bf16_f32 v37, v74, v75
    v_cvt_pk_bf16_f32 v38, v76, v77
    v_cvt_pk_bf16_f32 v39, v78, v79
    v_mfma_f32_32x32x16_bf16 v[112:127], v[144:147], v[208:211], 0
    v_cvt_pk_bf16_f32 v40, v80, v81
    v_cvt_pk_bf16_f32 v41, v82, v83
    v_cvt_pk_bf16_f32 v42, v84, v85
    v_cvt_pk_bf16_f32 v43, v86, v87
    v_mfma_f32_32x32x16_bf16 v[112:127], v[176:179], v[212:215], v[112:127]
    v_cvt_pk_bf16_f32 v44, v88, v89
    v_cvt_pk_bf16_f32 v45, v90, v91
    v_cvt_pk_bf16_f32 v46, v92, v93
    v_cvt_pk_bf16_f32 v47, v94, v95
    v_pk_mul_f32 v[220:221], v[218:219], v[218:219] op_sel:[0,0] op_sel_hi:[0,1]
    v_pk_fma_f32 v[220:221], v[218:219], v[218:219], v[220:221] op_sel:[1,1,0] op_sel_hi:[1,0,1] neg_lo:[1,0,0]
    v_pk_mul_f32 v[222:223], v[220:221], v[220:221] op_sel:[0,0] op_sel_hi:[0,1]
    v_pk_fma_f32 v[222:223], v[220:221], v[220:221], v[222:223] op_sel:[1,1,0] op_sel_hi:[1,0,1] neg_lo:[1,0,0]
    v_pk_mul_f32 v[130:131], v[230:231], v[218:219] op_sel:[0,0] op_sel_hi:[0,1]
    v_pk_fma_f32 v[130:131], v[230:231], v[218:219], v[130:131] op_sel:[1,1,0] op_sel_hi:[1,0,1] neg_lo:[1,0,0]
    v_pk_mul_f32 v[132:133], v[130:131], v[218:219] op_sel:[0,0] op_sel_hi:[0,1]
    v_pk_fma_f32 v[132:133], v[130:131], v[218:219], v[132:133] op_sel:[1,1,0] op_sel_hi:[1,0,1] neg_lo:[1,0,0]
    v_pk_mul_f32 v[134:135], v[132:133], v[218:219] op_sel:[0,0] op_sel_hi:[0,1]
    v_pk_fma_f32 v[134:135], v[132:133], v[218:219], v[134:135] op_sel:[1,1,0] op_sel_hi:[1,0,1] neg_lo:[1,0,0]
    v_pk_mul_f32 v[136:137], v[134:135], v[218:219] op_sel:[0,0] op_sel_hi:[0,1]
    v_pk_fma_f32 v[136:137], v[134:135], v[218:219], v[136:137] op_sel:[1,1,0] op_sel_hi:[1,0,1] neg_lo:[1,0,0]
    v_pk_mul_f32 v[138:139], v[136:137], v[218:219] op_sel:[0,0] op_sel_hi:[0,1]
    v_pk_fma_f32 v[138:139], v[136:137], v[218:219], v[138:139] op_sel:[1,1,0] op_sel_hi:[1,0,1] neg_lo:[1,0,0]
    v_pk_mul_f32 v[140:141], v[138:139], v[218:219] op_sel:[0,0] op_sel_hi:[0,1]
    v_pk_fma_f32 v[140:141], v[138:139], v[218:219], v[140:141] op_sel:[1,1,0] op_sel_hi:[1,0,1] neg_lo:[1,0,0]
    v_pk_mul_f32 v[142:143], v[140:141], v[218:219] op_sel:[0,0] op_sel_hi:[0,1]
    v_pk_fma_f32 v[142:143], v[140:141], v[218:219], v[142:143] op_sel:[1,1,0] op_sel_hi:[1,0,1] neg_lo:[1,0,0]
    v_pk_mul_f32 v[152:153], v[142:143], v[218:219] op_sel:[0,0] op_sel_hi:[0,1]
    v_pk_fma_f32 v[152:153], v[142:143], v[218:219], v[152:153] op_sel:[1,1,0] op_sel_hi:[1,0,1] neg_lo:[1,0,0]
    v_pk_mul_f32 v[146:147], v[230:231], v[226:227] op_sel:[0,0] op_sel_hi:[0,1]
    v_pk_fma_f32 v[146:147], v[230:231], v[226:227], v[146:147] op_sel:[1,1,0] op_sel_hi:[1,0,1] neg_lo:[1,0,0]
    v_pk_mul_f32 v[160:161], v[146:147], v[226:227] op_sel:[0,0] op_sel_hi:[0,1]
    v_pk_fma_f32 v[160:161], v[146:147], v[226:227], v[160:161] op_sel:[1,1,0] op_sel_hi:[1,0,1] neg_lo:[1,0,0]
    v_pk_mul_f32 v[168:169], v[160:161], v[226:227] op_sel:[0,0] op_sel_hi:[0,1]
    v_pk_fma_f32 v[168:169], v[160:161], v[226:227], v[168:169] op_sel:[1,1,0] op_sel_hi:[1,0,1] neg_lo:[1,0,0]
    v_pk_mul_f32 v[166:167], v[168:169], v[226:227] op_sel:[0,0] op_sel_hi:[0,1]
    v_pk_fma_f32 v[166:167], v[168:169], v[226:227], v[166:167] op_sel:[1,1,0] op_sel_hi:[1,0,1] neg_lo:[1,0,0]
    v_pk_mul_f32 v[178:179], v[166:167], v[226:227] op_sel:[0,0] op_sel_hi:[0,1]
    v_pk_fma_f32 v[178:179], v[166:167], v[226:227], v[178:179] op_sel:[1,1,0] op_sel_hi:[1,0,1] neg_lo:[1,0,0]
    v_pk_mul_f32 v[174:175], v[178:179], v[226:227] op_sel:[0,0] op_sel_hi:[0,1]
    v_pk_fma_f32 v[174:175], v[178:179], v[226:227], v[174:175] op_sel:[1,1,0] op_sel_hi:[1,0,1] neg_lo:[1,0,0]
    v_pk_mul_f32 v[186:187], v[174:175], v[226:227] op_sel:[0,0] op_sel_hi:[0,1]
    v_pk_fma_f32 v[186:187], v[174:175], v[226:227], v[186:187] op_sel:[1,1,0] op_sel_hi:[1,0,1] neg_lo:[1,0,0]
    v_pk_mul_f32 v[148:149], v[146:147], v[220:221] op_sel:[0,0] op_sel_hi:[0,1]
    v_pk_fma_f32 v[148:149], v[146:147], v[220:221], v[148:149] op_sel:[1,1,0] op_sel_hi:[1,0,1] neg_lo:[1,0,0]
    v_pk_mul_f32 v[150:151], v[148:149], v[220:221] op_sel:[0,0] op_sel_hi:[0,1]
    v_pk_fma_f32 v[150:151], v[148:149], v[220:221], v[150:151] op_sel:[1,1,0] op_sel_hi:[1,0,1] neg_lo:[1,0,0]
    v_pk_mul_f32 v[156:157], v[150:151], v[220:221] op_sel:[0,0] op_sel_hi:[0,1]
    v_pk_fma_f32 v[156:157], v[150:151], v[220:221], v[156:157] op_sel:[1,1,0] op_sel_hi:[1,0,1] neg_lo:[1,0,0]
    v_pk_mul_f32 v[158:159], v[156:157], v[220:221] op_sel:[0,0] op_sel_hi:[0,1]
    v_pk_fma_f32 v[158:159], v[156:157], v[220:221], v[158:159] op_sel:[1,1,0] op_sel_hi:[1,0,1] neg_lo:[1,0,0]
    v_pk_mul_f32 v[162:163], v[160:161], v[222:223] op_sel:[0,0] op_sel_hi:[0,1]
    v_pk_fma_f32 v[162:163], v[160:161], v[222:223], v[162:163] op_sel:[1,1,0] op_sel_hi:[1,0,1] neg_lo:[1,0,0]
    v_pk_mul_f32 v[164:165], v[160:161], v[224:225] op_sel:[0,0] op_sel_hi:[0,1]
    v_pk_fma_f32 v[164:165], v[160:161], v[224:225], v[164:165] op_sel:[1,1,0] op_sel_hi:[1,0,1] neg_lo:[1,0,0]
    v_pk_mul_f32 v[170:171], v[168:169], v[222:223] op_sel:[0,0] op_sel_hi:[0,1]
    v_pk_fma_f32 v[170:171], v[168:169], v[222:223], v[170:171] op_sel:[1,1,0] op_sel_hi:[1,0,1] neg_lo:[1,0,0]
    v_pk_mul_f32 v[172:173], v[168:169], v[224:225] op_sel:[0,0] op_sel_hi:[0,1]
    v_pk_fma_f32 v[172:173], v[168:169], v[224:225], v[172:173] op_sel:[1,1,0] op_sel_hi:[1,0,1] neg_lo:[1,0,0]
    v_pk_mul_f32 v[176:177], v[166:167], v[224:225] op_sel:[0,0] op_sel_hi:[0,1]
    v_pk_fma_f32 v[176:177], v[166:167], v[224:225], v[176:177] op_sel:[1,1,0] op_sel_hi:[1,0,1] neg_lo:[1,0,0]
    v_pk_mul_f32 v[180:181], v[178:179], v[224:225] op_sel:[0,0] op_sel_hi:[0,1]
    v_pk_fma_f32 v[180:181], v[178:179], v[224:225], v[180:181] op_sel:[1,1,0] op_sel_hi:[1,0,1] neg_lo:[1,0,0]
    v_pk_mul_f32 v[184:185], v[174:175], v[224:225] op_sel:[0,0] op_sel_hi:[0,1]
    v_pk_fma_f32 v[184:185], v[174:175], v[224:225], v[184:185] op_sel:[1,1,0] op_sel_hi:[1,0,1] neg_lo:[1,0,0]
    v_pk_mul_f32 v[188:189], v[186:187], v[224:225] op_sel:[0,0] op_sel_hi:[0,1]
    v_pk_fma_f32 v[188:189], v[186:187], v[224:225], v[188:189] op_sel:[1,1,0] op_sel_hi:[1,0,1] neg_lo:[1,0,0]
    v_cvt_pk_bf16_f32 v192, v230, v130
    v_cvt_pk_bf16_f32 v193, v132, v134
    v_cvt_pk_bf16_f32 v194, v136, v138
    v_cvt_pk_bf16_f32 v195, v140, v142
    v_cvt_pk_bf16_f32 v196, v136, v146
    v_cvt_pk_bf16_f32 v197, v148, v150
    v_cvt_pk_bf16_f32 v198, v152, v150
    v_cvt_pk_bf16_f32 v199, v156, v158
    v_cvt_pk_bf16_f32 v200, v160, v162
    v_cvt_pk_bf16_f32 v201, v164, v166
    v_cvt_pk_bf16_f32 v202, v168, v170
    v_cvt_pk_bf16_f32 v203, v172, v174
    v_cvt_pk_bf16_f32 v204, v176, v178
    v_cvt_pk_bf16_f32 v205, v180, v180
    v_cvt_pk_bf16_f32 v206, v184, v186
    v_cvt_pk_bf16_f32 v207, v188, v188
    v_permlane32_swap_b32 v192, v196
    v_permlane32_swap_b32 v193, v197
    v_permlane32_swap_b32 v194, v198
    v_permlane32_swap_b32 v195, v199
    v_permlane32_swap_b32 v200, v204
    v_permlane32_swap_b32 v201, v205
    v_permlane32_swap_b32 v202, v206
    v_permlane32_swap_b32 v203, v207
    v_mfma_f32_32x32x16_bf16 v[64:79], v[192:195], v[208:211], 0
    v_cvt_pk_bf16_f32 v48, v96, v97
    v_cvt_pk_bf16_f32 v49, v98, v99
    v_cvt_pk_bf16_f32 v50, v100, v101
    v_cvt_pk_bf16_f32 v51, v102, v103
    v_cvt_pk_bf16_f32 v52, v104, v105
    v_cvt_pk_bf16_f32 v53, v106, v107
    v_cvt_pk_bf16_f32 v54, v108, v109
    v_cvt_pk_bf16_f32 v55, v110, v111
    v_cvt_pk_bf16_f32 v56, v112, v113
    v_cvt_pk_bf16_f32 v57, v114, v115
    v_mfma_f32_32x32x16_bf16 v[64:79], v[200:203], v[212:215], v[64:79]
    v_cvt_pk_bf16_f32 v58, v116, v117
    v_cvt_pk_bf16_f32 v59, v118, v119
    v_cvt_pk_bf16_f32 v60, v120, v121
    v_cvt_pk_bf16_f32 v61, v122, v123
    v_cvt_pk_bf16_f32 v62, v124, v125
    v_cvt_pk_bf16_f32 v63, v126, v127
    v_cvt_pk_bf16_f32 v128, v231, v131
    v_cvt_pk_bf16_f32 v129, v133, v135
    v_cvt_pk_bf16_f32 v130, v137, v139
    v_cvt_pk_bf16_f32 v131, v141, v143
    v_mfma_f32_32x32x16_bf16 v[80:95], v[196:199], v[208:211], 0
    v_cvt_pk_bf16_f32 v144, v137, v147
    v_cvt_pk_bf16_f32 v145, v149, v151
    v_cvt_pk_bf16_f32 v146, v153, v151
    v_cvt_pk_bf16_f32 v147, v157, v159
    v_cvt_pk_bf16_f32 v160, v161, v163
    v_cvt_pk_bf16_f32 v161, v165, v167
    v_cvt_pk_bf16_f32 v162, v169, v171
    v_cvt_pk_bf16_f32 v163, v173, v175
    v_cvt_pk_bf16_f32 v176, v177, v179
    v_cvt_pk_bf16_f32 v177, v181, v181
    v_mfma_f32_32x32x16_bf16 v[80:95], v[204:207], v[212:215], v[80:95]
    v_cvt_pk_bf16_f32 v178, v185, v187
    v_cvt_pk_bf16_f32 v179, v189, v189
    v_permlane32_swap_b32 v128, v144
    v_permlane32_swap_b32 v129, v145
    v_permlane32_swap_b32 v130, v146
    v_permlane32_swap_b32 v131, v147
    v_permlane32_swap_b32 v160, v176
    v_permlane32_swap_b32 v161, v177
    v_permlane32_swap_b32 v162, v178
    v_permlane32_swap_b32 v163, v179
    v_mfma_f32_32x32x16_bf16 v[96:111], v[128:131], v[208:211], 0
    v_cvt_pk_bf16_f32 v64, v64, v65
    v_cvt_pk_bf16_f32 v65, v66, v67
    v_cvt_pk_bf16_f32 v66, v68, v69
    v_cvt_pk_bf16_f32 v67, v70, v71
    v_mfma_f32_32x32x16_bf16 v[96:111], v[160:163], v[212:215], v[96:111]
    v_cvt_pk_bf16_f32 v68, v72, v73
    v_cvt_pk_bf16_f32 v69, v74, v75
    v_cvt_pk_bf16_f32 v70, v76, v77
    v_cvt_pk_bf16_f32 v71, v78, v79
    v_mfma_f32_32x32x16_bf16 v[112:127], v[144:147], v[208:211], 0
    v_cvt_pk_bf16_f32 v80, v80, v81
    v_cvt_pk_bf16_f32 v81, v82, v83
    v_cvt_pk_bf16_f32 v82, v84, v85
    v_cvt_pk_bf16_f32 v83, v86, v87
    v_mfma_f32_32x32x16_bf16 v[112:127], v[176:179], v[212:215], v[112:127]
    v_cvt_pk_bf16_f32 v84, v88, v89
    v_cvt_pk_bf16_f32 v85, v90, v91
    v_cvt_pk_bf16_f32 v86, v92, v93
    v_cvt_pk_bf16_f32 v87, v94, v95
    v_mfma_f32_32x32x16_bf16 v[16:31], v[64:67], v[32:35], v[16:31]
    v_cvt_pk_bf16_f32 v96, v96, v97
    v_cvt_pk_bf16_f32 v97, v98, v99
    v_cvt_pk_bf16_f32 v98, v100, v101
    v_cvt_pk_bf16_f32 v99, v102, v103
    v_mfma_f32_32x32x16_bf16 v[16:31], v[68:71], v[36:39], v[16:31]
    v_cvt_pk_bf16_f32 v100, v104, v105
    v_cvt_pk_bf16_f32 v101, v106, v107
    v_cvt_pk_bf16_f32 v102, v108, v109
    v_cvt_pk_bf16_f32 v103, v110, v111
    v_mfma_f32_32x32x16_bf16 v[16:31], v[80:83], v[40:43], v[16:31]
    v_cvt_pk_bf16_f32 v112, v112, v113
    v_cvt_pk_bf16_f32 v113, v114, v115
    v_cvt_pk_bf16_f32 v114, v116, v117
    v_cvt_pk_bf16_f32 v115, v118, v119
    v_mfma_f32_32x32x16_bf16 v[16:31], v[84:87], v[44:47], v[16:31]
    v_cvt_pk_bf16_f32 v116, v120, v121
    v_cvt_pk_bf16_f32 v117, v122, v123
    v_cvt_pk_bf16_f32 v118, v124, v125
    v_cvt_pk_bf16_f32 v119, v126, v127
    s_add_u32 s73, s73, 1
    s_cmp_eq_u32 s73, 3
    s_cbranch_scc1 L_kexit
    s_cmp_eq_u32 s73, 2
    s_cbranch_scc1 L_ks2
    v_mfma_f32_32x32x16_bf16 v[16:31], v[96:99], v[48:51], v[16:31]
    v_mul_f32 v216, v4, v233
    v_mul_f32 v217, v4, v236
    v_mul_f32 v216, 0x3fb8aa3b, v216
    v_mul_f32 v217, 0x3e22f983, v217
    v_rndne_f32 v194, v217
    v_mul_f32 v192, v4, v239
    v_mfma_f32_32x32x16_bf16 v[16:31], v[100:103], v[52:55], v[16:31]
    v_mul_f32 v193, v4, v242
    v_sub_f32 v217, v217, v194
    v_mul_f32 v230, v245, v192
    v_mul_f32 v231, v245, v193
    v_fma_f32 v230, -v248, v193, v230
    v_fmac_f32 v231, v248, v192
    v_mfma_f32_32x32x16_bf16 v[16:31], v[112:115], v[56:59], v[16:31]
    v_mul_f32 v196, 0x41000000, v216
    v_mul_f32 v197, 0x41000000, v217
    v_exp_f32 v198, v196
    v_cos_f32 v224, v197
    v_sin_f32 v225, v197
    v_exp_f32 v202, v216
    v_mfma_f32_32x32x16_bf16 v[16:31], v[116:119], v[60:63], v[16:31]
    v_cos_f32 v218, v217
    v_sin_f32 v219, v217
    v_mul_f32 v204, 0x43800000, v216
    v_mul_f32 v205, 0x43800000, v217
    v_exp_f32 v206, v204
    v_cos_f32 v226, v205
    v_sin_f32 v227, v205
    v_mul_f32 v224, v224, v198
    v_mul_f32 v225, v225, v198
    v_mul_f32 v218, v218, v202
    v_mul_f32 v219, v219, v202
    v_mul_f32 v226, v226, v206
    v_mul_f32 v227, v227, v206
    s_branch L_kbody
L_ks2:
    s_waitcnt vmcnt(0)
    v_mfma_f32_32x32x16_bf16 v[16:31], v[96:99], v[48:51], v[16:31]
    v_mul_f32 v216, v4, v234
    v_mul_f32 v217, v4, v237
    v_mul_f32 v216, 0x3fb8aa3b, v216
    v_mul_f32 v217, 0x3e22f983, v217
    v_rndne_f32 v194, v217
    v_mul_f32 v192, v4, v240
    v_mfma_f32_32x32x16_bf16 v[16:31], v[100:103], v[52:55], v[16:31]
    v_mul_f32 v193, v4, v243
    v_sub_f32 v217, v217, v194
    v_mul_f32 v230, v246, v192
    v_mul_f32 v231, v246, v193
    v_fma_f32 v230, -v249, v193, v230
    v_fmac_f32 v231, v249, v192
    v_mfma_f32_32x32x16_bf16 v[16:31], v[112:115], v[56:59], v[16:31]
    v_mul_f32 v196, 0x41000000, v216
    v_mul_f32 v197, 0x41000000, v217
    v_exp_f32 v198, v196
    v_cos_f32 v224, v197
    v_sin_f32 v225, v197
    v_exp_f32 v202, v216
    v_mfma_f32_32x32x16_bf16 v[16:31], v[116:119], v[60:63], v[16:31]
    v_cos_f32 v218, v217
    v_sin_f32 v219, v217
    v_mul_f32 v204, 0x43800000, v216
    v_mul_f32 v205, 0x43800000, v217
    v_exp_f32 v206, v204
    v_cos_f32 v226, v205
    v_sin_f32 v227, v205
    v_mul_f32 v224, v224, v198
    v_mul_f32 v225, v225, v198
    v_mul_f32 v218, v218, v202
    v_mul_f32 v219, v219, v202
    v_mul_f32 v226, v226, v206
    v_mul_f32 v227, v227, v206
    s_branch L_kbody
L_kexit:
    s_load_dword s7, s[44:45], 0
    s_cmp_ge_u32 s3, 2
    s_cbranch_scc1 L_nogate0
    s_setprio 3
    s_mov_b64 s[52:53], s[16:17]
    v_and_b32 v5, 15, v0
    v_lshlrev_b32 v5, 4, v5
    v_lshrrev_b32 v1, 4, v0
    v_mul_u32_u24 v7, 1280, v1
    v_add_u32 v7, v7, v5
    s_lshl3_add_u32 s70, s5, s6
    s_lshl1_add_u32 s70, s70, s3
    s_mul_i32 s71, s70, 5120
    buffer_load_dwordx4 v[208:211], v7, s[52:55], s71 offen offset:0
    global_load_dwordx4 v[228:231], v5, s[40:41] offset:0
    buffer_load_dwordx4 v[212:215], v7, s[52:55], s71 offen offset:256
    global_load_dwordx4 v[232:235], v5, s[40:41] offset:256
    buffer_load_dwordx4 v[216:219], v7, s[52:55], s71 offen offset:512
    global_load_dwordx4 v[236:239], v5, s[40:41] offset:512
    buffer_load_dwordx4 v[220:223], v7, s[52:55], s71 offen offset:768
    global_load_dwordx4 v[240:243], v5, s[40:41] offset:768
    buffer_load_dwordx4 v[224:227], v7, s[52:55], s71 offen offset:1024
    global_load_dwordx4 v[244:247], v5, s[40:41] offset:1024
    s_setprio 0
L_nogate0:
    v_mfma_f32_32x32x16_bf16 v[16:31], v[96:99], v[48:51], v[16:31]
    v_and_b32 v6, 31, v0
    v_lshrrev_b32 v7, 5, v0
    v_lshlrev_b32 v8, 4, v6
    v_sub_u32 v8, s13, v8
    v_lshlrev_b32 v9, 3, v7
    v_sub_u32 v9, v8, v9
    v_mfma_f32_32x32x16_bf16 v[16:31], v[100:103], v[52:55], v[16:31]
    v_add_u32 v9, 504, v9
    v_lshlrev_b32 v10, 9, v7
    v_sub_u32 v10, v8, v10
    v_add_u32 v10, 1008, v10
    v_lshlrev_b32 v11, 10, v7
    v_sub_u32 v11, v8, v11
    v_mfma_f32_32x32x16_bf16 v[16:31], v[112:115], v[56:59], v[16:31]
    v_add_u32 v11, 1520, v11
    v_add_u32 v12, 8156, v9
    v_add_u32 v13, 7644, v9
    v_and_b32 v6, 1, v0
    v_cmp_eq_u32 vcc, 1, v6
    v_min_u32 v14, 27, v0
    v_mfma_f32_32x32x16_bf16 v[16:31], v[116:119], v[60:63], v[16:31]
    v_lshlrev_b32 v14, 4, v14
    v_add_u32 v14, s13, v14
    v_mov_b32 v196, 0
    v_mov_b32 v197, 0
    v_mov_b32 v198, 0
    v_mov_b32 v199, 0
    v_and_b32 v6, 15, v0
    v_lshrrev_b32 v7, 4, v0
    v_lshlrev_b32 v7, 4, v7
    v_add_u32 v7, s13, v7
    v_lshrrev_b32 v8, 1, v6
    v_lshlrev_b32 v8, 6, v8
    v_sub_u32 v8, v7, v8
    v_mov_b32 v202, 5024
    v_mov_b32 v203, 448
    v_cndmask_b32 v202, v202, v203, vcc
    v_add_u32 v2, v8, v202
    v_lshl_add_u32 v8, v6, 2, v7
    v_mov_b32 v202, 13440
    v_mov_b32 v203, 9220
    v_cndmask_b32 v202, v202, v203, vcc
    v_add_u32 v3, v8, v202
    v_mov_b32 v15, s13
    ds_write_b128 v14, v[196:199] offset:4096
    ds_write_b128 v14, v[196:199] offset:8672
    s_mov_b64 exec, 1
    v_add_f32 v16, s14, v16
    s_mov_b64 exec, -1
    v_cndmask_b32 v100, v27, v28, vcc
    v_cndmask_b32 v101, v29, v30, vcc
    v_cvt_pk_bf16_f32 v32, v19, v18
    v_cvt_pk_bf16_f32 v33, v17, v16
    v_cvt_pk_bf16_f32 v34, v23, v22
    v_cvt_pk_bf16_f32 v35, v21, v21
    v_cvt_pk_bf16_f32 v36, v26, v26
    v_cvt_pk_bf16_f32 v37, v25, v25
    v_cvt_pk_bf16_f32 v38, v25, v24
    v_cvt_pk_bf16_f32 v39, v24, v24
    v_cvt_pk_bf16_f32 v40, v26, v25
    v_mov_b32 v41, v37
    v_mov_b32 v42, v39
    v_mov_b32 v43, v39
    v_cvt_pk_bf16_f32 v44, v28, v28
    v_cvt_pk_bf16_f32 v45, v28, v100
    v_cvt_pk_bf16_f32 v46, v27, v27
    v_mov_b32 v47, v46
    v_mov_b32 v48, v44
    v_cvt_pk_bf16_f32 v49, v100, v27
    v_mov_b32 v50, v46
    v_mov_b32 v51, v46
    v_cvt_pk_bf16_f32 v52, v30, v30
    v_cvt_pk_bf16_f32 v53, v30, v101
    v_cvt_pk_bf16_f32 v54, v29, v29
    v_mov_b32 v55, v54
    v_mov_b32 v56, v52
    v_cvt_pk_bf16_f32 v57, v101, v29
    v_mov_b32 v58, v54
    v_mov_b32 v59, v54
    v_cvt_pk_bf16_f32 v60, v20, v19
    v_cvt_pk_bf16_f32 v61, v18, v17
    v_cvt_pk_bf16_f32 v62, v23, v23
    v_cvt_pk_bf16_f32 v63, v22, v21
    v_cvt_pk_bf16_f32 v102, v16, v196
    ds_write_b64 v9, v[32:33] offset:3584
    ds_write_b64 v9, v[34:35] offset:3072
    ds_write2_b32 v12, v60, v61 offset0:0 offset1:1
    ds_write2_b32 v13, v62, v63 offset0:0 offset1:1
    ds_write_b128 v10, v[36:39] offset:2048
    ds_write_b128 v10, v[40:43] offset:6624
    ds_write_b128 v11, v[44:47] offset:512
    ds_write_b128 v11, v[48:51] offset:5088
    ds_write_b128 v11, v[52:55] offset:0
    ds_write_b128 v11, v[56:59] offset:4576
    s_mov_b64 exec, 1
    ds_write_b32 v15, v102 offset:8668
    s_mov_b64 exec, -1
    s_waitcnt lgkmcnt(0)
    s_cmp_lg_u32 s7, 0
    s_cbranch_scc0 L_slow_12
L_back_13:
    s_mov_b32 s0, s7
    s_mov_b32 s1, s7
    s_waitcnt lgkmcnt(0)
    s_barrier
    s_setprio 0
    ds_read_b128 v[64:67], v2 offset:4032
    ds_read_b64 v[96:97], v3 offset:448
    ds_read_b64 v[98:99], v3 offset:456
    ds_read_b128 v[68:71], v2 offset:3520
    ds_read_b64 v[100:101], v3 offset:960
    ds_read_b64 v[102:103], v3 offset:968
    ds_read_b128 v[72:75], v2 offset:3008
    ds_read_b64 v[104:105], v3 offset:1472
    ds_read_b64 v[106:107], v3 offset:1480
    ds_read_b128 v[76:79], v2 offset:2496
    ds_read_b64 v[108:109], v3 offset:1984
    ds_read_b64 v[110:111], v3 offset:1992
    ds_read_b128 v[80:83], v2 offset:1984
    ds_read_b64 v[112:113], v3 offset:2496
    ds_read_b64 v[114:115], v3 offset:2504
    ds_read_b128 v[84:87], v2 offset:1472
    ds_read_b64 v[116:117], v3 offset:3008
    ds_read_b64 v[118:119], v3 offset:3016
    ds_read_b128 v[88:91], v2 offset:960
    ds_read_b64 v[120:121], v3 offset:3520
    ds_read_b64 v[122:123], v3 offset:3528
    ds_read_b128 v[92:95], v2 offset:448
    ds_read_b64 v[124:125], v3 offset:4032
    ds_read_b64 v[126:127], v3 offset:4040
    s_waitcnt lgkmcnt(0)
    v_mfma_f32_16x16x32_bf16 v[20:23], v[64:67], v[100:103], 0
    ds_read_b128 v[128:131], v2 offset:3968
    v_mfma_f32_16x16x32_bf16 v[32:35], v[64:67], v[112:115], 0
    ds_read_b64 v[160:161], v3 offset:384
    v_mfma_f32_16x16x32_bf16 v[36:39], v[64:67], v[116:119], 0
    ds_read_b64 v[162:163], v3 offset:392
    v_mfma_f32_16x16x32_bf16 v[40:43], v[64:67], v[120:123], 0
    ds_read_b128 v[132:135], v2 offset:3456
    v_mfma_f32_16x16x32_bf16 v[44:47], v[64:67], v[124:127], 0
    ds_read_b64 v[164:165], v3 offset:896
    v_mfma_f32_16x16x32_bf16 v[20:23], v[68:71], v[96:99], v[20:23]
    ds_read_b64 v[166:167], v3 offset:904
    v_mfma_f32_16x16x32_bf16 v[32:35], v[68:71], v[108:111], v[32:35]
    ds_read_b128 v[136:139], v2 offset:2944
    v_mfma_f32_16x16x32_bf16 v[36:39], v[68:71], v[112:115], v[36:39]
    ds_read_b64 v[168:169], v3 offset:1408
    v_mfma_f32_16x16x32_bf16 v[40:43], v[68:71], v[116:119], v[40:43]
    ds_read_b64 v[170:171], v3 offset:1416
    v_mfma_f32_16x16x32_bf16 v[44:47], v[68:71], v[120:123], v[44:47]
    ds_read_b128 v[140:143], v2 offset:2432
    v_mfma_f32_16x16x32_bf16 v[32:35], v[72:75], v[104:107], v[32:35]
    ds_read_b64 v[172:173], v3 offset:1920
    v_mfma_f32_16x16x32_bf16 v[36:39], v[72:75], v[108:111], v[36:39]
    ds_read_b64 v[174:175], v3 offset:1928
    v_mfma_f32_16x16x32_bf16 v[40:43], v[72:75], v[112:115], v[40:43]
    ds_read_b128 v[144:147], v2 offset:1920
    v_mfma_f32_16x16x32_bf16 v[44:47], v[72:75], v[116:119], v[44:47]
    ds_read_b64 v[176:177], v3 offset:2432
    v_mfma_f32_16x16x32_bf16 v[32:35], v[76:79], v[100:103], v[32:35]
    ds_read_b64 v[178:179], v3 offset:2440
    v_mfma_f32_16x16x32_bf16 v[36:39], v[76:79], v[104:107], v[36:39]
    ds_read_b128 v[148:151], v2 offset:1408
    v_mfma_f32_16x16x32_bf16 v[40:43], v[76:79], v[108:111], v[40:43]
    ds_read_b64 v[180:181], v3 offset:2944
    v_mfma_f32_16x16x32_bf16 v[44:47], v[76:79], v[112:115], v[44:47]
    ds_read_b64 v[182:183], v3 offset:2952
    v_mfma_f32_16x16x32_bf16 v[32:35], v[80:83], v[96:99], v[32:35]
    ds_read_b128 v[152:155], v2 offset:896
    v_mfma_f32_16x16x32_bf16 v[36:39], v[80:83], v[100:103], v[36:39]
    ds_read_b64 v[184:185], v3 offset:3456
    v_mfma_f32_16x16x32_bf16 v[40:43], v[80:83], v[104:107], v[40:43]
    ds_read_b64 v[186:187], v3 offset:3464
    v_mfma_f32_16x16x32_bf16 v[44:47], v[80:83], v[108:111], v[44:47]
    ds_read_b128 v[156:159], v2 offset:384
    v_mfma_f32_16x16x32_bf16 v[36:39], v[84:87], v[96:99], v[36:39]
    ds_read_b64 v[188:189], v3 offset:3968
    v_mfma_f32_16x16x32_bf16 v[40:43], v[84:87], v[100:103], v[40:43]
    ds_read_b64 v[190:191], v3 offset:3976
    v_mfma_f32_16x16x32_bf16 v[44:47], v[84:87], v[104:107], v[44:47]
    v_mfma_f32_16x16x32_bf16 v[40:43], v[88:91], v[96:99], v[40:43]
    v_mfma_f32_16x16x32_bf16 v[44:47], v[88:91], v[100:103], v[44:47]
    v_mfma_f32_16x16x32_bf16 v[44:47], v[92:95], v[96:99], v[44:47]
    s_waitcnt lgkmcnt(0)
    v_mfma_f32_16x16x32_bf16 v[20:23], v[128:131], v[164:167], v[20:23]
    ds_read_b128 v[64:67], v2 offset:3904
    v_mfma_f32_16x16x32_bf16 v[32:35], v[128:131], v[176:179], v[32:35]
    ds_read_b64 v[96:97], v3 offset:320
    v_mfma_f32_16x16x32_bf16 v[36:39], v[128:131], v[180:183], v[36:39]
    ds_read_b64 v[98:99], v3 offset:328
    v_mfma_f32_16x16x32_bf16 v[40:43], v[128:131], v[184:187], v[40:43]
    ds_read_b128 v[68:71], v2 offset:3392
    v_mfma_f32_16x16x32_bf16 v[44:47], v[128:131], v[188:191], v[44:47]
    ds_read_b64 v[100:101], v3 offset:832
    v_mfma_f32_16x16x32_bf16 v[20:23], v[132:135], v[160:163], v[20:23]
    ds_read_b64 v[102:103], v3 offset:840
    v_mfma_f32_16x16x32_bf16 v[32:35], v[132:135], v[172:175], v[32:35]
    ds_read_b128 v[72:75], v2 offset:2880
    v_mfma_f32_16x16x32_bf16 v[36:39], v[132:135], v[176:179], v[36:39]
    ds_read_b64 v[104:105], v3 offset:1344
    v_mfma_f32_16x16x32_bf16 v[40:43], v[132:135], v[180:183], v[40:43]
    ds_read_b64 v[106:107], v3 offset:1352
    v_mfma_f32_16x16x32_bf16 v[44:47], v[132:135], v[184:187], v[44:47]
    ds_read_b128 v[76:79], v2 offset:2368
    v_mfma_f32_16x16x32_bf16 v[32:35], v[136:139], v[168:171], v[32:35]
    ds_read_b64 v[108:109], v3 offset:1856
    v_mfma_f32_16x16x32_bf16 v[36:39], v[136:139], v[172:175], v[36:39]
    ds_read_b64 v[110:111], v3 offset:1864
    v_mfma_f32_16x16x32_bf16 v[40:43], v[136:139], v[176:179], v[40:43]
    ds_read_b128 v[80:83], v2 offset:1856
    v_mfma_f32_16x16x32_bf16 v[44:47], v[136:139], v[180:183], v[44:47]
    ds_read_b64 v[112:113], v3 offset:2368
    v_mfma_f32_16x16x32_bf16 v[32:35], v[140:143], v[164:167], v[32:35]
    ds_read_b64 v[114:115], v3 offset:2376
    v_mfma_f32_16x16x32_bf16 v[36:39], v[140:143], v[168:171], v[36:39]
    ds_read_b128 v[84:87], v2 offset:1344
    v_mfma_f32_16x16x32_bf16 v[40:43], v[140:143], v[172:175], v[40:43]
    ds_read_b64 v[116:117], v3 offset:2880
    v_mfma_f32_16x16x32_bf16 v[44:47], v[140:143], v[176:179], v[44:47]
    ds_read_b64 v[118:119], v3 offset:2888
    v_mfma_f32_16x16x32_bf16 v[32:35], v[144:147], v[160:163], v[32:35]
    ds_read_b128 v[88:91], v2 offset:832
    v_mfma_f32_16x16x32_bf16 v[36:39], v[144:147], v[164:167], v[36:39]
    ds_read_b64 v[120:121], v3 offset:3392
    v_mfma_f32_16x16x32_bf16 v[40:43], v[144:147], v[168:171], v[40:43]
    ds_read_b64 v[122:123], v3 offset:3400
    v_mfma_f32_16x16x32_bf16 v[44:47], v[144:147], v[172:175], v[44:47]
    ds_read_b128 v[92:95], v2 offset:320
    v_mfma_f32_16x16x32_bf16 v[36:39], v[148:151], v[160:163], v[36:39]
    ds_read_b64 v[124:125], v3 offset:3904
    v_mfma_f32_16x16x32_bf16 v[40:43], v[148:151], v[164:167], v[40:43]
    ds_read_b64 v[126:127], v3 offset:3912
    v_mfma_f32_16x16x32_bf16 v[44:47], v[148:151], v[168:171], v[44:47]
    v_mfma_f32_16x16x32_bf16 v[40:43], v[152:155], v[160:163], v[40:43]
    v_mfma_f32_16x16x32_bf16 v[44:47], v[152:155], v[164:167], v[44:47]
    v_mfma_f32_16x16x32_bf16 v[44:47], v[156:159], v[160:163], v[44:47]
    s_waitcnt lgkmcnt(0)
    v_mfma_f32_16x16x32_bf16 v[20:23], v[64:67], v[100:103], v[20:23]
    ds_read_b128 v[128:131], v2 offset:3840
    v_mfma_f32_16x16x32_bf16 v[32:35], v[64:67], v[112:115], v[32:35]
    ds_read_b64 v[160:161], v3 offset:256
    v_mfma_f32_16x16x32_bf16 v[36:39], v[64:67], v[116:119], v[36:39]
    ds_read_b64 v[162:163], v3 offset:264
    v_mfma_f32_16x16x32_bf16 v[40:43], v[64:67], v[120:123], v[40:43]
    ds_read_b128 v[132:135], v2 offset:3328
    v_mfma_f32_16x16x32_bf16 v[44:47], v[64:67], v[124:127], v[44:47]
    ds_read_b64 v[164:165], v3 offset:768
    v_mfma_f32_16x16x32_bf16 v[20:23], v[68:71], v[96:99], v[20:23]
    ds_read_b64 v[166:167], v3 offset:776
    v_mfma_f32_16x16x32_bf16 v[32:35], v[68:71], v[108:111], v[32:35]
    ds_read_b128 v[136:139], v2 offset:2816
    v_mfma_f32_16x16x32_bf16 v[36:39], v[68:71], v[112:115], v[36:39]
    ds_read_b64 v[168:169], v3 offset:1280
    v_mfma_f32_16x16x32_bf16 v[40:43], v[68:71], v[116:119], v[40:43]
    ds_read_b64 v[170:171], v3 offset:1288
    v_mfma_f32_16x16x32_bf16 v[44:47], v[68:71], v[120:123], v[44:47]
    ds_read_b128 v[140:143], v2 offset:2304
    v_mfma_f32_16x16x32_bf16 v[32:35], v[72:75], v[104:107], v[32:35]
    ds_read_b64 v[172:173], v3 offset:1792
    v_mfma_f32_16x16x32_bf16 v[36:39], v[72:75], v[108:111], v[36:39]
    ds_read_b64 v[174:175], v3 offset:1800
    v_mfma_f32_16x16x32_bf16 v[40:43], v[72:75], v[112:115], v[40:43]
    ds_read_b128 v[144:147], v2 offset:1792
    v_mfma_f32_16x16x32_bf16 v[44:47], v[72:75], v[116:119], v[44:47]
    ds_read_b64 v[176:177], v3 offset:2304
    v_mfma_f32_16x16x32_bf16 v[32:35], v[76:79], v[100:103], v[32:35]
    ds_read_b64 v[178:179], v3 offset:2312
    v_mfma_f32_16x16x32_bf16 v[36:39], v[76:79], v[104:107], v[36:39]
    ds_read_b128 v[148:151], v2 offset:1280
    v_mfma_f32_16x16x32_bf16 v[40:43], v[76:79], v[108:111], v[40:43]
    ds_read_b64 v[180:181], v3 offset:2816
    v_mfma_f32_16x16x32_bf16 v[44:47], v[76:79], v[112:115], v[44:47]
    ds_read_b64 v[182:183], v3 offset:2824
    v_mfma_f32_16x16x32_bf16 v[32:35], v[80:83], v[96:99], v[32:35]
    ds_read_b128 v[152:155], v2 offset:768
    v_mfma_f32_16x16x32_bf16 v[36:39], v[80:83], v[100:103], v[36:39]
    ds_read_b64 v[184:185], v3 offset:3328
    v_mfma_f32_16x16x32_bf16 v[40:43], v[80:83], v[104:107], v[40:43]
    ds_read_b64 v[186:187], v3 offset:3336
    v_mfma_f32_16x16x32_bf16 v[44:47], v[80:83], v[108:111], v[44:47]
    ds_read_b128 v[156:159], v2 offset:256
    v_mfma_f32_16x16x32_bf16 v[36:39], v[84:87], v[96:99], v[36:39]
    ds_read_b64 v[188:189], v3 offset:3840
    v_mfma_f32_16x16x32_bf16 v[40:43], v[84:87], v[100:103], v[40:43]
    ds_read_b64 v[190:191], v3 offset:3848
    v_mfma_f32_16x16x32_bf16 v[44:47], v[84:87], v[104:107], v[44:47]
    v_mfma_f32_16x16x32_bf16 v[40:43], v[88:91], v[96:99], v[40:43]
    v_mfma_f32_16x16x32_bf16 v[44:47], v[88:91], v[100:103], v[44:47]
    v_mfma_f32_16x16x32_bf16 v[44:47], v[92:95], v[96:99], v[44:47]
    s_waitcnt lgkmcnt(0)
    v_mfma_f32_16x16x32_bf16 v[20:23], v[128:131], v[164:167], v[20:23]
    ds_read_b128 v[64:67], v2 offset:3776
    v_mfma_f32_16x16x32_bf16 v[32:35], v[128:131], v[176:179], v[32:35]
    ds_read_b64 v[96:97], v3 offset:192
    v_mfma_f32_16x16x32_bf16 v[36:39], v[128:131], v[180:183], v[36:39]
    ds_read_b64 v[98:99], v3 offset:200
    v_mfma_f32_16x16x32_bf16 v[40:43], v[128:131], v[184:187], v[40:43]
    ds_read_b128 v[68:71], v2 offset:3264
    v_mfma_f32_16x16x32_bf16 v[44:47], v[128:131], v[188:191], v[44:47]
    ds_read_b64 v[100:101], v3 offset:704
    v_mfma_f32_16x16x32_bf16 v[20:23], v[132:135], v[160:163], v[20:23]
    ds_read_b64 v[102:103], v3 offset:712
    v_mfma_f32_16x16x32_bf16 v[32:35], v[132:135], v[172:175], v[32:35]
    ds_read_b128 v[72:75], v2 offset:2752
    v_mfma_f32_16x16x32_bf16 v[36:39], v[132:135], v[176:179], v[36:39]
    ds_read_b64 v[104:105], v3 offset:1216
    v_mfma_f32_16x16x32_bf16 v[40:43], v[132:135], v[180:183], v[40:43]
    ds_read_b64 v[106:107], v3 offset:1224
    v_mfma_f32_16x16x32_bf16 v[44:47], v[132:135], v[184:187], v[44:47]
    ds_read_b128 v[76:79], v2 offset:2240
    v_mfma_f32_16x16x32_bf16 v[32:35], v[136:139], v[168:171], v[32:35]
    ds_read_b64 v[108:109], v3 offset:1728
    v_mfma_f32_16x16x32_bf16 v[36:39], v[136:139], v[172:175], v[36:39]
    ds_read_b64 v[110:111], v3 offset:1736
    v_mfma_f32_16x16x32_bf16 v[40:43], v[136:139], v[176:179], v[40:43]
    ds_read_b128 v[80:83], v2 offset:1728
    v_mfma_f32_16x16x32_bf16 v[44:47], v[136:139], v[180:183], v[44:47]
    ds_read_b64 v[112:113], v3 offset:2240
    v_mfma_f32_16x16x32_bf16 v[32:35], v[140:143], v[164:167], v[32:35]
    ds_read_b64 v[114:115], v3 offset:2248
    v_mfma_f32_16x16x32_bf16 v[36:39], v[140:143], v[168:171], v[36:39]
    ds_read_b128 v[84:87], v2 offset:1216
    v_mfma_f32_16x16x32_bf16 v[40:43], v[140:143], v[172:175], v[40:43]
    ds_read_b64 v[116:117], v3 offset:2752
    v_mfma_f32_16x16x32_bf16 v[44:47], v[140:143], v[176:179], v[44:47]
    ds_read_b64 v[118:119], v3 offset:2760
    v_mfma_f32_16x16x32_bf16 v[32:35], v[144:147], v[160:163], v[32:35]
    ds_read_b128 v[88:91], v2 offset:704
    v_mfma_f32_16x16x32_bf16 v[36:39], v[144:147], v[164:167], v[36:39]
    ds_read_b64 v[120:121], v3 offset:3264
    v_mfma_f32_16x16x32_bf16 v[40:43], v[144:147], v[168:171], v[40:43]
    ds_read_b64 v[122:123], v3 offset:3272
    v_mfma_f32_16x16x32_bf16 v[44:47], v[144:147], v[172:175], v[44:47]
    ds_read_b128 v[92:95], v2 offset:192
    v_mfma_f32_16x16x32_bf16 v[36:39], v[148:151], v[160:163], v[36:39]
    ds_read_b64 v[124:125], v3 offset:3776
    v_mfma_f32_16x16x32_bf16 v[40:43], v[148:151], v[164:167], v[40:43]
    ds_read_b64 v[126:127], v3 offset:3784
    v_mfma_f32_16x16x32_bf16 v[44:47], v[148:151], v[168:171], v[44:47]
    v_mfma_f32_16x16x32_bf16 v[40:43], v[152:155], v[160:163], v[40:43]
    v_mfma_f32_16x16x32_bf16 v[44:47], v[152:155], v[164:167], v[44:47]
    v_mfma_f32_16x16x32_bf16 v[44:47], v[156:159], v[160:163], v[44:47]
    s_waitcnt lgkmcnt(0)
    v_mfma_f32_16x16x32_bf16 v[20:23], v[64:67], v[100:103], v[20:23]
    ds_read_b128 v[128:131], v2 offset:3712
    v_mfma_f32_16x16x32_bf16 v[32:35], v[64:67], v[112:115], v[32:35]
    ds_read_b64 v[160:161], v3 offset:128
    v_mfma_f32_16x16x32_bf16 v[36:39], v[64:67], v[116:119], v[36:39]
    ds_read_b64 v[162:163], v3 offset:136
    v_mfma_f32_16x16x32_bf16 v[40:43], v[64:67], v[120:123], v[40:43]
    ds_read_b128 v[132:135], v2 offset:3200
    v_mfma_f32_16x16x32_bf16 v[44:47], v[64:67], v[124:127], v[44:47]
    ds_read_b64 v[164:165], v3 offset:640
    v_mfma_f32_16x16x32_bf16 v[20:23], v[68:71], v[96:99], v[20:23]
    ds_read_b64 v[166:167], v3 offset:648
    v_mfma_f32_16x16x32_bf16 v[32:35], v[68:71], v[108:111], v[32:35]
    ds_read_b128 v[136:139], v2 offset:2688
    v_mfma_f32_16x16x32_bf16 v[36:39], v[68:71], v[112:115], v[36:39]
    ds_read_b64 v[168:169], v3 offset:1152
    v_mfma_f32_16x16x32_bf16 v[40:43], v[68:71], v[116:119], v[40:43]
    ds_read_b64 v[170:171], v3 offset:1160
    v_mfma_f32_16x16x32_bf16 v[44:47], v[68:71], v[120:123], v[44:47]
    ds_read_b128 v[140:143], v2 offset:2176
    v_mfma_f32_16x16x32_bf16 v[32:35], v[72:75], v[104:107], v[32:35]
    ds_read_b64 v[172:173], v3 offset:1664
    v_mfma_f32_16x16x32_bf16 v[36:39], v[72:75], v[108:111], v[36:39]
    ds_read_b64 v[174:175], v3 offset:1672
    v_mfma_f32_16x16x32_bf16 v[40:43], v[72:75], v[112:115], v[40:43]
    ds_read_b128 v[144:147], v2 offset:1664
    v_mfma_f32_16x16x32_bf16 v[44:47], v[72:75], v[116:119], v[44:47]
    ds_read_b64 v[176:177], v3 offset:2176
    v_mfma_f32_16x16x32_bf16 v[32:35], v[76:79], v[100:103], v[32:35]
    ds_read_b64 v[178:179], v3 offset:2184
    v_mfma_f32_16x16x32_bf16 v[36:39], v[76:79], v[104:107], v[36:39]
    ds_read_b128 v[148:151], v2 offset:1152
    v_mfma_f32_16x16x32_bf16 v[40:43], v[76:79], v[108:111], v[40:43]
    ds_read_b64 v[180:181], v3 offset:2688
    v_mfma_f32_16x16x32_bf16 v[44:47], v[76:79], v[112:115], v[44:47]
    ds_read_b64 v[182:183], v3 offset:2696
    v_mfma_f32_16x16x32_bf16 v[32:35], v[80:83], v[96:99], v[32:35]
    ds_read_b128 v[152:155], v2 offset:640
    v_mfma_f32_16x16x32_bf16 v[36:39], v[80:83], v[100:103], v[36:39]
    ds_read_b64 v[184:185], v3 offset:3200
    v_mfma_f32_16x16x32_bf16 v[40:43], v[80:83], v[104:107], v[40:43]
    ds_read_b64 v[186:187], v3 offset:3208
    v_mfma_f32_16x16x32_bf16 v[44:47], v[80:83], v[108:111], v[44:47]
    ds_read_b128 v[156:159], v2 offset:128
    v_mfma_f32_16x16x32_bf16 v[36:39], v[84:87], v[96:99], v[36:39]
    ds_read_b64 v[188:189], v3 offset:3712
    v_mfma_f32_16x16x32_bf16 v[40:43], v[84:87], v[100:103], v[40:43]
    ds_read_b64 v[190:191], v3 offset:3720
    v_mfma_f32_16x16x32_bf16 v[44:47], v[84:87], v[104:107], v[44:47]
    v_mfma_f32_16x16x32_bf16 v[40:43], v[88:91], v[96:99], v[40:43]
    v_mfma_f32_16x16x32_bf16 v[44:47], v[88:91], v[100:103], v[44:47]
    v_mfma_f32_16x16x32_bf16 v[44:47], v[92:95], v[96:99], v[44:47]
    s_waitcnt lgkmcnt(0)
    v_mfma_f32_16x16x32_bf16 v[20:23], v[128:131], v[164:167], v[20:23]
    ds_read_b128 v[64:67], v2 offset:3648
    v_mfma_f32_16x16x32_bf16 v[32:35], v[128:131], v[176:179], v[32:35]
    ds_read_b64 v[96:97], v3 offset:64
    v_mfma_f32_16x16x32_bf16 v[36:39], v[128:131], v[180:183], v[36:39]
    ds_read_b64 v[98:99], v3 offset:72
    v_mfma_f32_16x16x32_bf16 v[40:43], v[128:131], v[184:187], v[40:43]
    ds_read_b128 v[68:71], v2 offset:3136
    v_mfma_f32_16x16x32_bf16 v[44:47], v[128:131], v[188:191], v[44:47]
    ds_read_b64 v[100:101], v3 offset:576
    v_mfma_f32_16x16x32_bf16 v[20:23], v[132:135], v[160:163], v[20:23]
    ds_read_b64 v[102:103], v3 offset:584
    v_mfma_f32_16x16x32_bf16 v[32:35], v[132:135], v[172:175], v[32:35]
    ds_read_b128 v[72:75], v2 offset:2624
    v_mfma_f32_16x16x32_bf16 v[36:39], v[132:135], v[176:179], v[36:39]
    ds_read_b64 v[104:105], v3 offset:1088
    v_mfma_f32_16x16x32_bf16 v[40:43], v[132:135], v[180:183], v[40:43]
    ds_read_b64 v[106:107], v3 offset:1096
    v_mfma_f32_16x16x32_bf16 v[44:47], v[132:135], v[184:187], v[44:47]
    ds_read_b128 v[76:79], v2 offset:2112
    v_mfma_f32_16x16x32_bf16 v[32:35], v[136:139], v[168:171], v[32:35]
    ds_read_b64 v[108:109], v3 offset:1600
    v_mfma_f32_16x16x32_bf16 v[36:39], v[136:139], v[172:175], v[36:39]
    ds_read_b64 v[110:111], v3 offset:1608
    v_mfma_f32_16x16x32_bf16 v[40:43], v[136:139], v[176:179], v[40:43]
    ds_read_b128 v[80:83], v2 offset:1600
    v_mfma_f32_16x16x32_bf16 v[44:47], v[136:139], v[180:183], v[44:47]
    ds_read_b64 v[112:113], v3 offset:2112
    v_mfma_f32_16x16x32_bf16 v[32:35], v[140:143], v[164:167], v[32:35]
    ds_read_b64 v[114:115], v3 offset:2120
    v_mfma_f32_16x16x32_bf16 v[36:39], v[140:143], v[168:171], v[36:39]
    ds_read_b128 v[84:87], v2 offset:1088
    v_mfma_f32_16x16x32_bf16 v[40:43], v[140:143], v[172:175], v[40:43]
    ds_read_b64 v[116:117], v3 offset:2624
    v_mfma_f32_16x16x32_bf16 v[44:47], v[140:143], v[176:179], v[44:47]
    ds_read_b64 v[118:119], v3 offset:2632
    v_mfma_f32_16x16x32_bf16 v[32:35], v[144:147], v[160:163], v[32:35]
    ds_read_b128 v[88:91], v2 offset:576
    v_mfma_f32_16x16x32_bf16 v[36:39], v[144:147], v[164:167], v[36:39]
    ds_read_b64 v[120:121], v3 offset:3136
    v_mfma_f32_16x16x32_bf16 v[40:43], v[144:147], v[168:171], v[40:43]
    ds_read_b64 v[122:123], v3 offset:3144
    v_mfma_f32_16x16x32_bf16 v[44:47], v[144:147], v[172:175], v[44:47]
    ds_read_b128 v[92:95], v2 offset:64
    v_mfma_f32_16x16x32_bf16 v[36:39], v[148:151], v[160:163], v[36:39]
    ds_read_b64 v[124:125], v3 offset:3648
    v_mfma_f32_16x16x32_bf16 v[40:43], v[148:151], v[164:167], v[40:43]
    ds_read_b64 v[126:127], v3 offset:3656
    v_mfma_f32_16x16x32_bf16 v[44:47], v[148:151], v[168:171], v[44:47]
    v_mfma_f32_16x16x32_bf16 v[40:43], v[152:155], v[160:163], v[40:43]
    v_mfma_f32_16x16x32_bf16 v[44:47], v[152:155], v[164:167], v[44:47]
    v_mfma_f32_16x16x32_bf16 v[44:47], v[156:159], v[160:163], v[44:47]
    s_waitcnt lgkmcnt(0)
    v_mfma_f32_16x16x32_bf16 v[20:23], v[64:67], v[100:103], v[20:23]
    ds_read_b128 v[128:131], v2 offset:3584
    v_mfma_f32_16x16x32_bf16 v[32:35], v[64:67], v[112:115], v[32:35]
    ds_read_b64 v[160:161], v3 offset:0
    v_mfma_f32_16x16x32_bf16 v[36:39], v[64:67], v[116:119], v[36:39]
    ds_read_b64 v[162:163], v3 offset:8
    v_mfma_f32_16x16x32_bf16 v[40:43], v[64:67], v[120:123], v[40:43]
    ds_read_b128 v[132:135], v2 offset:3072
    v_mfma_f32_16x16x32_bf16 v[44:47], v[64:67], v[124:127], v[44:47]
    ds_read_b64 v[164:165], v3 offset:512
    v_mfma_f32_16x16x32_bf16 v[20:23], v[68:71], v[96:99], v[20:23]
    ds_read_b64 v[166:167], v3 offset:520
    v_mfma_f32_16x16x32_bf16 v[32:35], v[68:71], v[108:111], v[32:35]
    ds_read_b128 v[136:139], v2 offset:2560
    v_mfma_f32_16x16x32_bf16 v[36:39], v[68:71], v[112:115], v[36:39]
    ds_read_b64 v[168:169], v3 offset:1024
    v_mfma_f32_16x16x32_bf16 v[40:43], v[68:71], v[116:119], v[40:43]
    ds_read_b64 v[170:171], v3 offset:1032
    v_mfma_f32_16x16x32_bf16 v[44:47], v[68:71], v[120:123], v[44:47]
    ds_read_b128 v[140:143], v2 offset:2048
    v_mfma_f32_16x16x32_bf16 v[32:35], v[72:75], v[104:107], v[32:35]
    ds_read_b64 v[172:173], v3 offset:1536
    v_mfma_f32_16x16x32_bf16 v[36:39], v[72:75], v[108:111], v[36:39]
    ds_read_b64 v[174:175], v3 offset:1544
    v_mfma_f32_16x16x32_bf16 v[40:43], v[72:75], v[112:115], v[40:43]
    ds_read_b128 v[144:147], v2 offset:1536
    v_mfma_f32_16x16x32_bf16 v[44:47], v[72:75], v[116:119], v[44:47]
    ds_read_b64 v[176:177], v3 offset:2048
    v_mfma_f32_16x16x32_bf16 v[32:35], v[76:79], v[100:103], v[32:35]
    ds_read_b64 v[178:179], v3 offset:2056
    v_mfma_f32_16x16x32_bf16 v[36:39], v[76:79], v[104:107], v[36:39]
    ds_read_b128 v[148:151], v2 offset:1024
    v_mfma_f32_16x16x32_bf16 v[40:43], v[76:79], v[108:111], v[40:43]
    ds_read_b64 v[180:181], v3 offset:2560
    v_mfma_f32_16x16x32_bf16 v[44:47], v[76:79], v[112:115], v[44:47]
    ds_read_b64 v[182:183], v3 offset:2568
    v_mfma_f32_16x16x32_bf16 v[32:35], v[80:83], v[96:99], v[32:35]
    ds_read_b128 v[152:155], v2 offset:512
    v_mfma_f32_16x16x32_bf16 v[36:39], v[80:83], v[100:103], v[36:39]
    ds_read_b64 v[184:185], v3 offset:3072
    v_mfma_f32_16x16x32_bf16 v[40:43], v[80:83], v[104:107], v[40:43]
    ds_read_b64 v[186:187], v3 offset:3080
    v_mfma_f32_16x16x32_bf16 v[44:47], v[80:83], v[108:111], v[44:47]
    ds_read_b128 v[156:159], v2 offset:0
    v_mfma_f32_16x16x32_bf16 v[36:39], v[84:87], v[96:99], v[36:39]
    ds_read_b64 v[188:189], v3 offset:3584
    v_mfma_f32_16x16x32_bf16 v[40:43], v[84:87], v[100:103], v[40:43]
    ds_read_b64 v[190:191], v3 offset:3592
    v_mfma_f32_16x16x32_bf16 v[44:47], v[84:87], v[104:107], v[44:47]
    v_mfma_f32_16x16x32_bf16 v[40:43], v[88:91], v[96:99], v[40:43]
    v_mfma_f32_16x16x32_bf16 v[44:47], v[88:91], v[100:103], v[44:47]
    v_mfma_f32_16x16x32_bf16 v[44:47], v[92:95], v[96:99], v[44:47]
    s_waitcnt lgkmcnt(0)
    v_mfma_f32_16x16x32_bf16 v[20:23], v[128:131], v[164:167], v[20:23]
    v_lshlrev_b32 v8, 3, v0
    v_mfma_f32_16x16x32_bf16 v[32:35], v[128:131], v[176:179], v[32:35]
    s_lshl_b32 s64, s12, 12
    v_mfma_f32_16x16x32_bf16 v[36:39], v[128:131], v[180:183], v[36:39]
    s_add_u32 s64, s64, 0x300000
    v_mfma_f32_16x16x32_bf16 v[40:43], v[128:131], v[184:187], v[40:43]
    v_mfma_f32_16x16x32_bf16 v[44:47], v[128:131], v[188:191], v[44:47]
    v_mfma_f32_16x16x32_bf16 v[20:23], v[132:135], v[160:163], v[20:23]
    v_mfma_f32_16x16x32_bf16 v[32:35], v[132:135], v[172:175], v[32:35]
    v_mfma_f32_16x16x32_bf16 v[36:39], v[132:135], v[176:179], v[36:39]
    v_mfma_f32_16x16x32_bf16 v[40:43], v[132:135], v[180:183], v[40:43]
    v_mfma_f32_16x16x32_bf16 v[44:47], v[132:135], v[184:187], v[44:47]
    v_mfma_f32_16x16x32_bf16 v[32:35], v[136:139], v[168:171], v[32:35]
    v_mfma_f32_16x16x32_bf16 v[36:39], v[136:139], v[172:175], v[36:39]
    v_mfma_f32_16x16x32_bf16 v[40:43], v[136:139], v[176:179], v[40:43]
    v_mfma_f32_16x16x32_bf16 v[44:47], v[136:139], v[180:183], v[44:47]
    v_mfma_f32_16x16x32_bf16 v[32:35], v[140:143], v[164:167], v[32:35]
    v_mfma_f32_16x16x32_bf16 v[36:39], v[140:143], v[168:171], v[36:39]
    v_mfma_f32_16x16x32_bf16 v[40:43], v[140:143], v[172:175], v[40:43]
    v_mfma_f32_16x16x32_bf16 v[44:47], v[140:143], v[176:179], v[44:47]
    v_mfma_f32_16x16x32_bf16 v[32:35], v[144:147], v[160:163], v[32:35]
    v_mfma_f32_16x16x32_bf16 v[36:39], v[144:147], v[164:167], v[36:39]
    v_mfma_f32_16x16x32_bf16 v[40:43], v[144:147], v[168:171], v[40:43]
    v_mfma_f32_16x16x32_bf16 v[44:47], v[144:147], v[172:175], v[44:47]
    v_mfma_f32_16x16x32_bf16 v[36:39], v[148:151], v[160:163], v[36:39]
    v_mfma_f32_16x16x32_bf16 v[40:43], v[148:151], v[164:167], v[40:43]
    v_mfma_f32_16x16x32_bf16 v[44:47], v[148:151], v[168:171], v[44:47]
    v_mfma_f32_16x16x32_bf16 v[40:43], v[152:155], v[160:163], v[40:43]
    v_mfma_f32_16x16x32_bf16 v[44:47], v[152:155], v[164:167], v[44:47]
    v_mfma_f32_16x16x32_bf16 v[44:47], v[156:159], v[160:163], v[44:47]
    s_setprio 3
    v_cvt_pk_bf16_f32 v66, v20, v21
    v_cvt_pk_bf16_f32 v67, v22, v23
    buffer_store_dwordx2 v[66:67], v8, s[48:51], s64 offen offset:512 sc1
    v_cvt_pk_bf16_f32 v72, v32, v33
    v_cvt_pk_bf16_f32 v73, v34, v35
    buffer_store_dwordx2 v[72:73], v8, s[48:51], s64 offen offset:2048 sc1
    v_cvt_pk_bf16_f32 v74, v36, v37
    v_cvt_pk_bf16_f32 v75, v38, v39
    buffer_store_dwordx2 v[74:75], v8, s[48:51], s64 offen offset:2560 sc1
    v_cvt_pk_bf16_f32 v76, v40, v41
    v_cvt_pk_bf16_f32 v77, v42, v43
    buffer_store_dwordx2 v[76:77], v8, s[48:51], s64 offen offset:3072 sc1
    v_cvt_pk_bf16_f32 v78, v44, v45
    v_cvt_pk_bf16_f32 v79, v46, v47
    buffer_store_dwordx2 v[78:79], v8, s[48:51], s64 offen offset:3584 sc1
    s_cmp_ge_u32 s3, 2
    s_cbranch_scc1 L_nogate
    s_setprio 0
    v_mov_b32 v160, 0
    v_mov_b32 v161, 0
    s_waitcnt vmcnt(13)
    v_lshlrev_b32 v152, 16, v208
    v_and_b32 v153, 0xffff0000, v208
    v_lshlrev_b32 v154, 16, v228
    v_and_b32 v155, 0xffff0000, v228
    v_mul_f32 v152, v152, v154
    v_mul_f32 v153, v153, v155
    v_cvt_pk_bf16_f32 v156, v152, v153
    v_lshlrev_b32 v152, 16, v156
    v_and_b32 v153, 0xffff0000, v156
    v_add_f32 v160, v160, v152
    v_add_f32 v161, v161, v153
    v_lshlrev_b32 v152, 16, v209
    v_and_b32 v153, 0xffff0000, v209
    v_lshlrev_b32 v154, 16, v229
    v_and_b32 v155, 0xffff0000, v229
    v_mul_f32 v152, v152, v154
    v_mul_f32 v153, v153, v155
    v_cvt_pk_bf16_f32 v156, v152, v153
    v_lshlrev_b32 v152, 16, v156
    v_and_b32 v153, 0xffff0000, v156
    v_add_f32 v160, v160, v152
    v_add_f32 v161, v161, v153
    v_lshlrev_b32 v152, 16, v210
    v_and_b32 v153, 0xffff0000, v210
    v_lshlrev_b32 v154, 16, v230
    v_and_b32 v155, 0xffff0000, v230
    v_mul_f32 v152, v152, v154
    v_mul_f32 v153, v153, v155
    v_cvt_pk_bf16_f32 v156, v152, v153
    v_lshlrev_b32 v152, 16, v156
    v_and_b32 v153, 0xffff0000, v156
    v_add_f32 v160, v160, v152
    v_add_f32 v161, v161, v153
    v_lshlrev_b32 v152, 16, v211
    v_and_b32 v153, 0xffff0000, v211
    v_lshlrev_b32 v154, 16, v231
    v_and_b32 v155, 0xffff0000, v231
    v_mul_f32 v152, v152, v154
    v_mul_f32 v153, v153, v155
    v_cvt_pk_bf16_f32 v156, v152, v153
    v_lshlrev_b32 v152, 16, v156
    v_and_b32 v153, 0xffff0000, v156
    v_add_f32 v160, v160, v152
    v_add_f32 v161, v161, v153
    s_waitcnt vmcnt(11)
    v_lshlrev_b32 v152, 16, v212
    v_and_b32 v153, 0xffff0000, v212
    v_lshlrev_b32 v154, 16, v232
    v_and_b32 v155, 0xffff0000, v232
    v_mul_f32 v152, v152, v154
    v_mul_f32 v153, v153, v155
    v_cvt_pk_bf16_f32 v156, v152, v153
    v_lshlrev_b32 v152, 16, v156
    v_and_b32 v153, 0xffff0000, v156
    v_add_f32 v160, v160, v152
    v_add_f32 v161, v161, v153
    v_lshlrev_b32 v152, 16, v213
    v_and_b32 v153, 0xffff0000, v213
    v_lshlrev_b32 v154, 16, v233
    v_and_b32 v155, 0xffff0000, v233
    v_mul_f32 v152, v152, v154
    v_mul_f32 v153, v153, v155
    v_cvt_pk_bf16_f32 v156, v152, v153
    v_lshlrev_b32 v152, 16, v156
    v_and_b32 v153, 0xffff0000, v156
    v_add_f32 v160, v160, v152
    v_add_f32 v161, v161, v153
    v_lshlrev_b32 v152, 16, v214
    v_and_b32 v153, 0xffff0000, v214
    v_lshlrev_b32 v154, 16, v234
    v_and_b32 v155, 0xffff0000, v234
    v_mul_f32 v152, v152, v154
    v_mul_f32 v153, v153, v155
    v_cvt_pk_bf16_f32 v156, v152, v153
    v_lshlrev_b32 v152, 16, v156
    v_and_b32 v153, 0xffff0000, v156
    v_add_f32 v160, v160, v152
    v_add_f32 v161, v161, v153
    v_lshlrev_b32 v152, 16, v215
    v_and_b32 v153, 0xffff0000, v215
    v_lshlrev_b32 v154, 16, v235
    v_and_b32 v155, 0xffff0000, v235
    v_mul_f32 v152, v152, v154
    v_mul_f32 v153, v153, v155
    v_cvt_pk_bf16_f32 v156, v152, v153
    v_lshlrev_b32 v152, 16, v156
    v_and_b32 v153, 0xffff0000, v156
    v_add_f32 v160, v160, v152
    v_add_f32 v161, v161, v153
    s_waitcnt vmcnt(9)
    v_lshlrev_b32 v152, 16, v216
    v_and_b32 v153, 0xffff0000, v216
    v_lshlrev_b32 v154, 16, v236
    v_and_b32 v155, 0xffff0000, v236
    v_mul_f32 v152, v152, v154
    v_mul_f32 v153, v153, v155
    v_cvt_pk_bf16_f32 v156, v152, v153
    v_lshlrev_b32 v152, 16, v156
    v_and_b32 v153, 0xffff0000, v156
    v_add_f32 v160, v160, v152
    v_add_f32 v161, v161, v153
    v_lshlrev_b32 v152, 16, v217
    v_and_b32 v153, 0xffff0000, v217
    v_lshlrev_b32 v154, 16, v237
    v_and_b32 v155, 0xffff0000, v237
    v_mul_f32 v152, v152, v154
    v_mul_f32 v153, v153, v155
    v_cvt_pk_bf16_f32 v156, v152, v153
    v_lshlrev_b32 v152, 16, v156
    v_and_b32 v153, 0xffff0000, v156
    v_add_f32 v160, v160, v152
    v_add_f32 v161, v161, v153
    v_lshlrev_b32 v152, 16, v218
    v_and_b32 v153, 0xffff0000, v218
    v_lshlrev_b32 v154, 16, v238
    v_and_b32 v155, 0xffff0000, v238
    v_mul_f32 v152, v152, v154
    v_mul_f32 v153, v153, v155
    v_cvt_pk_bf16_f32 v156, v152, v153
    v_lshlrev_b32 v152, 16, v156
    v_and_b32 v153, 0xffff0000, v156
    v_add_f32 v160, v160, v152
    v_add_f32 v161, v161, v153
    v_lshlrev_b32 v152, 16, v219
    v_and_b32 v153, 0xffff0000, v219
    v_lshlrev_b32 v154, 16, v239
    v_and_b32 v155, 0xffff0000, v239
    v_mul_f32 v152, v152, v154
    v_mul_f32 v153, v153, v155
    v_cvt_pk_bf16_f32 v156, v152, v153
    v_lshlrev_b32 v152, 16, v156
    v_and_b32 v153, 0xffff0000, v156
    v_add_f32 v160, v160, v152
    v_add_f32 v161, v161, v153
    s_waitcnt vmcnt(7)
    v_lshlrev_b32 v152, 16, v220
    v_and_b32 v153, 0xffff0000, v220
    v_lshlrev_b32 v154, 16, v240
    v_and_b32 v155, 0xffff0000, v240
    v_mul_f32 v152, v152, v154
    v_mul_f32 v153, v153, v155
    v_cvt_pk_bf16_f32 v156, v152, v153
    v_lshlrev_b32 v152, 16, v156
    v_and_b32 v153, 0xffff0000, v156
    v_add_f32 v160, v160, v152
    v_add_f32 v161, v161, v153
    v_lshlrev_b32 v152, 16, v221
    v_and_b32 v153, 0xffff0000, v221
    v_lshlrev_b32 v154, 16, v241
    v_and_b32 v155, 0xffff0000, v241
    v_mul_f32 v152, v152, v154
    v_mul_f32 v153, v153, v155
    v_cvt_pk_bf16_f32 v156, v152, v153
    v_lshlrev_b32 v152, 16, v156
    v_and_b32 v153, 0xffff0000, v156
    v_add_f32 v160, v160, v152
    v_add_f32 v161, v161, v153
    v_lshlrev_b32 v152, 16, v222
    v_and_b32 v153, 0xffff0000, v222
    v_lshlrev_b32 v154, 16, v242
    v_and_b32 v155, 0xffff0000, v242
    v_mul_f32 v152, v152, v154
    v_mul_f32 v153, v153, v155
    v_cvt_pk_bf16_f32 v156, v152, v153
    v_lshlrev_b32 v152, 16, v156
    v_and_b32 v153, 0xffff0000, v156
    v_add_f32 v160, v160, v152
    v_add_f32 v161, v161, v153
    v_lshlrev_b32 v152, 16, v223
    v_and_b32 v153, 0xffff0000, v223
    v_lshlrev_b32 v154, 16, v243
    v_and_b32 v155, 0xffff0000, v243
    v_mul_f32 v152, v152, v154
    v_mul_f32 v153, v153, v155
    v_cvt_pk_bf16_f32 v156, v152, v153
    v_lshlrev_b32 v152, 16, v156
    v_and_b32 v153, 0xffff0000, v156
    v_add_f32 v160, v160, v152
    v_add_f32 v161, v161, v153
    s_waitcnt vmcnt(5)
    v_lshlrev_b32 v152, 16, v224
    v_and_b32 v153, 0xffff0000, v224
    v_lshlrev_b32 v154, 16, v244
    v_and_b32 v155, 0xffff0000, v244
    v_mul_f32 v152, v152, v154
    v_mul_f32 v153, v153, v155
    v_cvt_pk_bf16_f32 v156, v152, v153
    v_lshlrev_b32 v152, 16, v156
    v_and_b32 v153, 0xffff0000, v156
    v_add_f32 v160, v160, v152
    v_add_f32 v161, v161, v153
    v_lshlrev_b32 v152, 16, v225
    v_and_b32 v153, 0xffff0000, v225
    v_lshlrev_b32 v154, 16, v245
    v_and_b32 v155, 0xffff0000, v245
    v_mul_f32 v152, v152, v154
    v_mul_f32 v153, v153, v155
    v_cvt_pk_bf16_f32 v156, v152, v153
    v_lshlrev_b32 v152, 16, v156
    v_and_b32 v153, 0xffff0000, v156
    v_add_f32 v160, v160, v152
    v_add_f32 v161, v161, v153
    v_lshlrev_b32 v152, 16, v226
    v_and_b32 v153, 0xffff0000, v226
    v_lshlrev_b32 v154, 16, v246
    v_and_b32 v155, 0xffff0000, v246
    v_mul_f32 v152, v152, v154
    v_mul_f32 v153, v153, v155
    v_cvt_pk_bf16_f32 v156, v152, v153
    v_lshlrev_b32 v152, 16, v156
    v_and_b32 v153, 0xffff0000, v156
    v_add_f32 v160, v160, v152
    v_add_f32 v161, v161, v153
    v_lshlrev_b32 v152, 16, v227
    v_and_b32 v153, 0xffff0000, v227
    v_lshlrev_b32 v154, 16, v247
    v_and_b32 v155, 0xffff0000, v247
    v_mul_f32 v152, v152, v154
    v_mul_f32 v153, v153, v155
    v_cvt_pk_bf16_f32 v156, v152, v153
    v_lshlrev_b32 v152, 16, v156
    v_and_b32 v153, 0xffff0000, v156
    v_add_f32 v160, v160, v152
    v_add_f32 v161, v161, v153
    v_add_f32 v160, v160, v161
    s_nop 1
    v_add_f32_dpp v160, v160, v160 quad_perm:[1,0,3,2] row_mask:0xf bank_mask:0xf
    s_nop 1
    v_add_f32_dpp v160, v160, v160 quad_perm:[2,3,0,1] row_mask:0xf bank_mask:0xf
    s_nop 1
    v_add_f32_dpp v160, v160, v160 row_half_mirror row_mask:0xf bank_mask:0xf
    s_nop 1
    v_add_f32_dpp v160, v160, v160 row_mirror row_mask:0xf bank_mask:0xf
    v_cvt_pk_bf16_f32 v160, v160, v160
    v_lshlrev_b32 v160, 16, v160
    v_mul_f32 v160, 0xbfb8aa3b, v160
    v_exp_f32 v160, v160
    s_nop 0
    v_add_f32 v160, 1.0, v160
    v_rcp_f32 v160, v160
    s_nop 0
    v_cvt_pk_bf16_f32 v160, v160, v160
    v_lshlrev_b32 v160, 16, v160
    v_mov_b32 v161, s7
    v_lshlrev_b32 v6, 3, v1
    s_lshl_b32 s70, s70, 5
    s_add_u32 s70, s70, 0xe00000
    s_mov_b32 s74, 0x00010001
    s_mov_b32 s75, 0x00010001
    s_mov_b64 exec, s[74:75]
    buffer_store_dwordx2 v[160:161], v6, s[48:51], s70 offen sc1
    s_mov_b64 exec, -1
    s_waitcnt vmcnt(1)
    s_branch L_gdone
L_nogate:
    s_waitcnt vmcnt(0)
L_gdone:
    s_barrier
    s_endpgm
L_misc_main:
    v_lshrrev_b32 v1, 4, v0
    v_bfe_u32 v2, v0, 2, 2
    v_and_b32 v3, 3, v0
    v_lshl_add_u32 v4, v1, 3, v2
    v_mul_u32_u24 v4, 160, v4
    v_lshl_add_u32 v4, v3, 3, v4
    v_add_u32 v18, 52992, v4
    v_and_b32 v5, 15, v0
    v_lshlrev_b32 v5, 12, v5
    v_lshl_add_u32 v19, v1, 4, v5
    v_and_b32 v5, 15, v0
    v_and_b32 v6, 7, v0
    v_xor_b32 v16, v1, v6
    v_lshlrev_b32 v16, 4, v16
    v_lshl_add_u32 v16, v5, 7, v16
    v_xor_b32 v14, 64, v16
    v_add_u32 v16, 71424, v16
    v_add_u32 v14, 71424, v14
    v_lshrrev_b32 v5, 3, v0
    v_xor_b32 v17, v5, v6
    v_lshlrev_b32 v17, 4, v17
    v_lshl_add_u32 v17, v5, 7, v17
    v_add_u32 v17, 71424, v17
    v_lshlrev_b32 v6, 4, v6
    v_lshl_add_u32 v19, v5, 12, v6
    v_lshrrev_b32 v5, 1, v1
    v_and_b32 v6, 1, v1
    v_lshlrev_b32 v5, 4, v5
    v_lshl_add_u32 v5, v6, 2, v5
    v_add_u32 v5, v5, v2
    v_lshlrev_b32 v5, 8, v5
    v_lshl_add_u32 v5, v3, 3, v5
    v_add_u32 v20, 63232, v5
    v_lshlrev_b32 v21, 4, v0
    s_mul_i32 s72, s6, 327680
    s_lshl_b32 s73, s5, 7
    s_add_u32 s72, s72, s73
    s_lshr_b32 s73, s5, 3
    s_lshl2_add_u32 s73, s6, s73
    s_lshl_b32 s73, s73, 5
    s_and_b32 s74, s5, 7
    s_add_u32 s73, s73, s74
    s_lshl_b32 s73, s73, 2
    s_add_u32 s77, s73, 0xe10000
    s_waitcnt vmcnt(8)
    ds_read_b64_tr_b16 v[24:25], v18 offset:0
    ds_read_b64_tr_b16 v[26:27], v18 offset:640
    ds_read_b64_tr_b16 v[28:29], v18 offset:5120
    ds_read_b64_tr_b16 v[30:31], v18 offset:5760
    ds_read_b64_tr_b16 v[32:33], v18 offset:32
    ds_read_b64_tr_b16 v[34:35], v18 offset:672
    ds_read_b64_tr_b16 v[36:37], v18 offset:5152
    ds_read_b64_tr_b16 v[38:39], v18 offset:5792
    ds_read_b64_tr_b16 v[40:41], v18 offset:64
    ds_read_b64_tr_b16 v[42:43], v18 offset:704
    ds_read_b64_tr_b16 v[44:45], v18 offset:5184
    ds_read_b64_tr_b16 v[46:47], v18 offset:5824
    ds_read_b64_tr_b16 v[48:49], v18 offset:96
    ds_read_b64_tr_b16 v[50:51], v18 offset:736
    ds_read_b64_tr_b16 v[52:53], v18 offset:5216
    ds_read_b64_tr_b16 v[54:55], v18 offset:5856
    ds_read_b64_tr_b16 v[56:57], v18 offset:128
    ds_read_b64_tr_b16 v[58:59], v18 offset:768
    ds_read_b64_tr_b16 v[60:61], v18 offset:5248
    ds_read_b64_tr_b16 v[62:63], v18 offset:5888
    s_waitcnt lgkmcnt(15)
    ds_write_b128 v16, v[24:27] offset:0
    ds_write_b128 v14, v[28:31] offset:0
    s_waitcnt lgkmcnt(14)
    ds_write_b128 v16, v[32:35] offset:2048
    ds_write_b128 v14, v[36:39] offset:2048
    s_waitcnt lgkmcnt(12)
    ds_write_b128 v16, v[40:43] offset:4096
    ds_write_b128 v14, v[44:47] offset:4096
    s_waitcnt lgkmcnt(10)
    ds_write_b128 v16, v[48:51] offset:6144
    ds_write_b128 v14, v[52:55] offset:6144
    s_waitcnt lgkmcnt(8)
    ds_write_b128 v16, v[56:59] offset:8192
    ds_write_b128 v14, v[60:63] offset:8192
    ds_read_b128 v[96:99], v17 offset:0
    ds_read_b128 v[100:103], v17 offset:1024
    ds_read_b128 v[104:107], v17 offset:2048
    ds_read_b128 v[108:111], v17 offset:3072
    ds_read_b128 v[112:115], v17 offset:4096
    ds_read_b128 v[116:119], v17 offset:5120
    ds_read_b128 v[120:123], v17 offset:6144
    ds_read_b128 v[124:127], v17 offset:7168
    ds_read_b128 v[128:131], v17 offset:8192
    ds_read_b128 v[132:135], v17 offset:9216
    s_waitcnt lgkmcnt(9)
    buffer_store_dwordx4 v[96:99], v19, s[48:51], s72 offen sc1
    s_add_u32 s72, s72, 32768
    s_waitcnt lgkmcnt(8)
    buffer_store_dwordx4 v[100:103], v19, s[48:51], s72 offen sc1
    s_add_u32 s72, s72, 32768
    s_waitcnt lgkmcnt(7)
    buffer_store_dwordx4 v[104:107], v19, s[48:51], s72 offen sc1
    s_add_u32 s72, s72, 32768
    s_waitcnt lgkmcnt(6)
    buffer_store_dwordx4 v[108:111], v19, s[48:51], s72 offen sc1
    s_add_u32 s72, s72, 32768
    s_waitcnt lgkmcnt(5)
    buffer_store_dwordx4 v[112:115], v19, s[48:51], s72 offen sc1
    s_add_u32 s72, s72, 32768
    s_waitcnt lgkmcnt(4)
    buffer_store_dwordx4 v[116:119], v19, s[48:51], s72 offen sc1
    s_add_u32 s72, s72, 32768
    s_waitcnt lgkmcnt(3)
    buffer_store_dwordx4 v[120:123], v19, s[48:51], s72 offen sc1
    s_add_u32 s72, s72, 32768
    s_waitcnt lgkmcnt(2)
    buffer_store_dwordx4 v[124:127], v19, s[48:51], s72 offen sc1
    s_add_u32 s72, s72, 32768
    s_waitcnt lgkmcnt(1)
    buffer_store_dwordx4 v[128:131], v19, s[48:51], s72 offen sc1
    s_add_u32 s72, s72, 32768
    s_waitcnt lgkmcnt(0)
    buffer_store_dwordx4 v[132:135], v19, s[48:51], s72 offen sc1
    s_add_u32 s72, s72, 32768
    s_load_dword s7, s[44:45], 0
    s_waitcnt lgkmcnt(0)
    s_cmp_lg_u32 s7, 0
    s_cbranch_scc0 L_slow_1
L_back_2:
    s_mov_b32 s0, s7
    s_mov_b32 s1, s7
    s_waitcnt vmcnt(0)
    v_mov_b32 v8, s7
    v_mul_u32_u24 v9, 4096, v0
    s_mov_b64 exec, 3
    buffer_store_dword v8, v9, s[48:51], s77 offen sc1
    s_mov_b64 exec, -1
    s_waitcnt vmcnt(0)
    ds_read_b64_tr_b16 v[64:65], v20 offset:0
    ds_read_b64_tr_b16 v[66:67], v20 offset:2048
    ds_read_b64_tr_b16 v[68:69], v20 offset:32
    ds_read_b64_tr_b16 v[70:71], v20 offset:2080
    ds_read_b64_tr_b16 v[72:73], v20 offset:64
    ds_read_b64_tr_b16 v[74:75], v20 offset:2112
    ds_read_b64_tr_b16 v[76:77], v20 offset:96
    ds_read_b64_tr_b16 v[78:79], v20 offset:2144
    ds_read_b64_tr_b16 v[80:81], v20 offset:128
    ds_read_b64_tr_b16 v[82:83], v20 offset:2176
    ds_read_b64_tr_b16 v[84:85], v20 offset:160
    ds_read_b64_tr_b16 v[86:87], v20 offset:2208
    ds_read_b64_tr_b16 v[88:89], v20 offset:192
    ds_read_b64_tr_b16 v[90:91], v20 offset:2240
    ds_read_b64_tr_b16 v[92:93], v20 offset:224
    ds_read_b64_tr_b16 v[94:95], v20 offset:2272
    s_mul_i32 s74, s67, 43
    s_lshr_b32 s74, s74, 8
    s_mul_i32 s75, s74, 6
    s_sub_u32 s75, s67, s75
    s_lshr_b32 s76, s75, 1
    s_mul_i32 s76, s76, 14
    s_add_u32 s76, s76, s75
    s_lshl1_add_u32 s76, s74, s76
    s_lshl_b32 s73, s68, 3
    s_add_u32 s73, s73, 0
    s_mul_i32 s74, s73, 205
    s_lshr_b32 s74, s74, 10
    s_mul_i32 s75, s74, 235
    s_add_u32 s75, s75, s73
    s_lshl_b32 s74, s74, 1
    s_xor_b32 s74, s74, s76
    s_mul_i32 s74, s74, 5
    s_add_u32 s75, s75, s74
    s_lshl_b32 s75, s75, 10
    s_add_u32 s75, s75, 0xc00000
    s_waitcnt lgkmcnt(14)
    buffer_store_dwordx4 v[64:67], v21, s[48:51], s75 offen sc1
    s_lshl_b32 s73, s68, 3
    s_add_u32 s73, s73, 1
    s_mul_i32 s74, s73, 205
    s_lshr_b32 s74, s74, 10
    s_mul_i32 s75, s74, 235
    s_add_u32 s75, s75, s73
    s_lshl_b32 s74, s74, 1
    s_xor_b32 s74, s74, s76
    s_mul_i32 s74, s74, 5
    s_add_u32 s75, s75, s74
    s_lshl_b32 s75, s75, 10
    s_add_u32 s75, s75, 0xc00000
    s_waitcnt lgkmcnt(12)
    buffer_store_dwordx4 v[68:71], v21, s[48:51], s75 offen sc1
    s_lshl_b32 s73, s68, 3
    s_add_u32 s73, s73, 2
    s_mul_i32 s74, s73, 205
    s_lshr_b32 s74, s74, 10
    s_mul_i32 s75, s74, 235
    s_add_u32 s75, s75, s73
    s_lshl_b32 s74, s74, 1
    s_xor_b32 s74, s74, s76
    s_mul_i32 s74, s74, 5
    s_add_u32 s75, s75, s74
    s_lshl_b32 s75, s75, 10
    s_add_u32 s75, s75, 0xc00000
    s_waitcnt lgkmcnt(10)
    buffer_store_dwordx4 v[72:75], v21, s[48:51], s75 offen sc1
    s_lshl_b32 s73, s68, 3
    s_add_u32 s73, s73, 3
    s_mul_i32 s74, s73, 205
    s_lshr_b32 s74, s74, 10
    s_mul_i32 s75, s74, 235
    s_add_u32 s75, s75, s73
    s_lshl_b32 s74, s74, 1
    s_xor_b32 s74, s74, s76
    s_mul_i32 s74, s74, 5
    s_add_u32 s75, s75, s74
    s_lshl_b32 s75, s75, 10
    s_add_u32 s75, s75, 0xc00000
    s_waitcnt lgkmcnt(8)
    buffer_store_dwordx4 v[76:79], v21, s[48:51], s75 offen sc1
    s_lshl_b32 s73, s68, 3
    s_add_u32 s73, s73, 4
    s_mul_i32 s74, s73, 205
    s_lshr_b32 s74, s74, 10
    s_mul_i32 s75, s74, 235
    s_add_u32 s75, s75, s73
    s_lshl_b32 s74, s74, 1
    s_xor_b32 s74, s74, s76
    s_mul_i32 s74, s74, 5
    s_add_u32 s75, s75, s74
    s_lshl_b32 s75, s75, 10
    s_add_u32 s75, s75, 0xc00000
    s_waitcnt lgkmcnt(6)
    buffer_store_dwordx4 v[80:83], v21, s[48:51], s75 offen sc1
    s_lshl_b32 s73, s68, 3
    s_add_u32 s73, s73, 5
    s_mul_i32 s74, s73, 205
    s_lshr_b32 s74, s74, 10
    s_mul_i32 s75, s74, 235
    s_add_u32 s75, s75, s73
    s_lshl_b32 s74, s74, 1
    s_xor_b32 s74, s74, s76
    s_mul_i32 s74, s74, 5
    s_add_u32 s75, s75, s74
    s_lshl_b32 s75, s75, 10
    s_add_u32 s75, s75, 0xc00000
    s_waitcnt lgkmcnt(4)
    buffer_store_dwordx4 v[84:87], v21, s[48:51], s75 offen sc1
    s_lshl_b32 s73, s68, 3
    s_add_u32 s73, s73, 6
    s_mul_i32 s74, s73, 205
    s_lshr_b32 s74, s74, 10
    s_mul_i32 s75, s74, 235
    s_add_u32 s75, s75, s73
    s_lshl_b32 s74, s74, 1
    s_xor_b32 s74, s74, s76
    s_mul_i32 s74, s74, 5
    s_add_u32 s75, s75, s74
    s_lshl_b32 s75, s75, 10
    s_add_u32 s75, s75, 0xc00000
    s_waitcnt lgkmcnt(2)
    buffer_store_dwordx4 v[88:91], v21, s[48:51], s75 offen sc1
    s_lshl_b32 s73, s68, 3
    s_add_u32 s73, s73, 7
    s_mul_i32 s74, s73, 205
    s_lshr_b32 s74, s74, 10
    s_mul_i32 s75, s74, 235
    s_add_u32 s75, s75, s73
    s_lshl_b32 s74, s74, 1
    s_xor_b32 s74, s74, s76
    s_mul_i32 s74, s74, 5
    s_add_u32 s75, s75, s74
    s_lshl_b32 s75, s75, 10
    s_add_u32 s75, s75, 0xc00000
    s_waitcnt lgkmcnt(0)
    buffer_store_dwordx4 v[92:95], v21, s[48:51], s75 offen sc1
    s_lshl_b32 s73, s68, 6
    s_add_u32 s73, s73, s67
    s_lshl_b32 s73, s73, 2
    s_add_u32 s73, s73, 0xe28000
    s_mul_i32 s60, s4, 3
    s_lshl_b32 s61, s4, 1
    s_add_u32 s61, s61, 128
    s_cmp_lt_u32 s4, 128
    s_cselect_b32 s60, s60, s61
    s_cselect_b32 s61, 3, 2
    v_lshrrev_b32 v1, 4, v0
    v_min_u32 v1, 2, v1
    v_mul_u32_u24 v22, 17664, v1
    v_and_b32 v2, 15, v0
    v_lshl_add_u32 v1, v2, 2, v22
    v_mov_b32 v2, 0
    ds_write_b32 v1, v2 offset:9216
    ds_write_b32 v1, v2 offset:13440
    v_bfe_u32 v1, v0, 3, 2
    v_and_b32 v23, 7, v0
    v_lshlrev_b32 v23, 2, v23
    v_lshl_add_u32 v23, v1, 7, v23
    v_and_b32 v6, 1, v0
    v_cmp_eq_u32 vcc, 1, v6
    v_and_b32 v6, 15, v0
    v_lshrrev_b32 v7, 4, v0
    v_lshlrev_b32 v7, 4, v7
    v_lshrrev_b32 v5, 1, v6
    v_lshlrev_b32 v5, 6, v5
    v_sub_u32 v5, v7, v5
    v_mov_b32 v2, 5024
    v_mov_b32 v3, 448
    v_cndmask_b32 v2, v2, v3, vcc
    v_add_u32 v2, v5, v2
    v_lshl_add_u32 v5, v6, 2, v7
    v_mov_b32 v3, 13440
    v_mov_b32 v4, 9220
    v_cndmask_b32 v3, v3, v4, vcc
    v_add_u32 v3, v5, v3
    v_lshlrev_b32 v4, 3, v0
    s_mul_i32 s64, s60, 205
    s_lshr_b32 s64, s64, 14
    s_add_u32 s65, s60, s61
    s_sub_u32 s65, s65, 1
    s_mul_i32 s65, s65, 205
    s_lshr_b32 s65, s65, 14
    s_waitcnt vmcnt(0)
    v_mov_b32 v8, s7
    v_mov_b32 v9, 0
    s_mov_b64 exec, 1
    buffer_store_dword v8, v9, s[48:51], s73 offen sc1
    s_mov_b64 exec, -1
    s_waitcnt vmcnt(0)
L_ugrp:
    s_lshl_b32 s9, s64, 9
    s_add_u32 s9, s9, 0xe10000
    s_mov_b32 s62, s9
    s_add_u32 s63, s9, 8192
L_sp_7:
    s_cmp_ge_u32 s62, s63
    s_cbranch_scc1 L_sp_fb_9
    s_load_dwordx8 s[16:23], s[48:49], s62 offset:0
    s_load_dwordx8 s[24:31], s[48:49], s62 offset:128
    s_load_dwordx8 s[32:39], s[48:49], s62 offset:256
    s_load_dwordx8 s[40:47], s[48:49], s62 offset:384
    s_add_u32 s62, s62, 4096
    s_waitcnt lgkmcnt(0)
    s_xor_b64 s[16:17], s[16:17], s[0:1]
    s_xor_b64 s[18:19], s[18:19], s[0:1]
    s_xor_b64 s[20:21], s[20:21], s[0:1]
    s_xor_b64 s[22:23], s[22:23], s[0:1]
    s_xor_b64 s[24:25], s[24:25], s[0:1]
    s_xor_b64 s[26:27], s[26:27], s[0:1]
    s_xor_b64 s[28:29], s[28:29], s[0:1]
    s_xor_b64 s[30:31], s[30:31], s[0:1]
    s_xor_b64 s[32:33], s[32:33], s[0:1]
    s_xor_b64 s[34:35], s[34:35], s[0:1]
    s_xor_b64 s[36:37], s[36:37], s[0:1]
    s_xor_b64 s[38:39], s[38:39], s[0:1]
    s_xor_b64 s[40:41], s[40:41], s[0:1]
    s_xor_b64 s[42:43], s[42:43], s[0:1]
    s_xor_b64 s[44:45], s[44:45], s[0:1]
    s_xor_b64 s[46:47], s[46:47], s[0:1]
    s_or_b64 s[16:17], s[16:17], s[18:19]
    s_or_b64 s[16:17], s[16:17], s[20:21]
    s_or_b64 s[16:17], s[16:17], s[22:23]
    s_or_b64 s[16:17], s[16:17], s[24:25]
    s_or_b64 s[16:17], s[16:17], s[26:27]
    s_or_b64 s[16:17], s[16:17], s[28:29]
    s_or_b64 s[16:17], s[16:17], s[30:31]
    s_or_b64 s[16:17], s[16:17], s[32:33]
    s_or_b64 s[16:17], s[16:17], s[34:35]
    s_or_b64 s[16:17], s[16:17], s[36:37]
    s_or_b64 s[16:17], s[16:17], s[38:39]
    s_or_b64 s[16:17], s[16:17], s[40:41]
    s_or_b64 s[16:17], s[16:17], s[42:43]
    s_or_b64 s[16:17], s[16:17], s[44:45]
    s_or_b64 s[16:17], s[16:17], s[46:47]
    s_cbranch_scc0 L_sp_ok_8
    s_sleep 8
    s_branch L_sp_7
L_sp_fb_9:
    s_mov_b32 s8, 0x100000
    s_mov_b64 vcc, -1
L_poll_10:
    s_mov_b64 exec, vcc
    buffer_load_dword v24, v23, s[48:51], s9 offen sc1
    s_mov_b64 exec, -1
    s_waitcnt vmcnt(0)
    v_cmp_ne_u32 vcc, s7, v24
    s_nop 0
    s_cmp_eq_u64 vcc, 0
    s_cbranch_scc1 L_poll_ok_11
    s_sleep 2
    s_sub_u32 s8, s8, 1
    s_cmp_lg_u32 s8, 0
    s_cbranch_scc1 L_poll_10
L_poll_ok_11:
L_sp_ok_8:
    s_add_u32 s64, s64, 1
    s_cmp_le_u32 s64, s65
    s_cbranch_scc1 L_ugrp
    s_waitcnt vmcnt(1)
    s_lshl_b32 s64, s60, 12
    s_add_u32 s65, s64, 4
    s_mov_b32 m0, 9280
    s_nop 0
    buffer_load_dwordx4 v21, s[48:51], s64 offen offset:0 sc1 lds
    buffer_load_dwordx4 v21, s[48:51], s64 offen offset:1024 sc1 lds
    buffer_load_dwordx4 v21, s[48:51], s64 offen offset:2048 sc1 lds
    buffer_load_dwordx4 v21, s[48:51], s64 offen offset:3072 sc1 lds
    s_mov_b32 m0, 13504
    s_nop 0
    buffer_load_dwordx4 v21, s[48:51], s65 offen offset:0 sc1 lds
    buffer_load_dwordx4 v21, s[48:51], s65 offen offset:1024 sc1 lds
    buffer_load_dwordx4 v21, s[48:51], s65 offen offset:2048 sc1 lds
    buffer_load_dwordx4 v21, s[48:51], s65 offen offset:3072 sc1 lds
    s_add_u32 s64, s64, 4096
    s_add_u32 s65, s64, 4
    s_mov_b32 m0, 26944
    s_nop 0
    buffer_load_dwordx4 v21, s[48:51], s64 offen offset:0 sc1 lds
    buffer_load_dwordx4 v21, s[48:51], s64 offen offset:1024 sc1 lds
    buffer_load_dwordx4 v21, s[48:51], s64 offen offset:2048 sc1 lds
    buffer_load_dwordx4 v21, s[48:51], s64 offen offset:3072 sc1 lds
    s_mov_b32 m0, 31168
    s_nop 0
    buffer_load_dwordx4 v21, s[48:51], s65 offen offset:0 sc1 lds
    buffer_load_dwordx4 v21, s[48:51], s65 offen offset:1024 sc1 lds
    buffer_load_dwordx4 v21, s[48:51], s65 offen offset:2048 sc1 lds
    buffer_load_dwordx4 v21, s[48:51], s65 offen offset:3072 sc1 lds
    s_add_u32 s64, s64, 4096
    s_cmp_lt_u32 s61, 3
    s_cbranch_scc1 L_u2
    s_add_u32 s65, s64, 4
    s_mov_b32 m0, 44608
    s_nop 0
    buffer_load_dwordx4 v21, s[48:51], s64 offen offset:0 sc1 lds
    buffer_load_dwordx4 v21, s[48:51], s64 offen offset:1024 sc1 lds
    buffer_load_dwordx4 v21, s[48:51], s64 offen offset:2048 sc1 lds
    buffer_load_dwordx4 v21, s[48:51], s64 offen offset:3072 sc1 lds
    s_mov_b32 m0, 48832
    s_nop 0
    buffer_load_dwordx4 v21, s[48:51], s65 offen offset:0 sc1 lds
    buffer_load_dwordx4 v21, s[48:51], s65 offen offset:1024 sc1 lds
    buffer_load_dwordx4 v21, s[48:51], s65 offen offset:2048 sc1 lds
    buffer_load_dwordx4 v21, s[48:51], s65 offen offset:3072 sc1 lds
    s_add_u32 s64, s64, 4096
L_u2:
    s_waitcnt vmcnt(0)
    ds_read_b32 v1, v22 offset:9280
    s_waitcnt lgkmcnt(0)
    ds_write_b32 v22, v1 offset:13500
    s_waitcnt lgkmcnt(0)
    s_barrier
    s_setprio 0
    s_lshl_b32 s64, s60, 12
    s_add_u32 s64, s64, 0x300000
    ds_read_b128 v[96:99], v2 offset:4032
    ds_read_b64 v[112:113], v3 offset:448
    ds_read_b64 v[114:115], v3 offset:456
    ds_read_b128 v[100:103], v2 offset:3520
    ds_read_b64 v[116:117], v3 offset:960
    ds_read_b64 v[118:119], v3 offset:968
    ds_read_b128 v[104:107], v2 offset:3008
    ds_read_b64 v[120:121], v3 offset:1472
    ds_read_b64 v[122:123], v3 offset:1480
    ds_read_b128 v[108:111], v2 offset:2496
    ds_read_b64 v[124:125], v3 offset:1984
    ds_read_b64 v[126:127], v3 offset:1992
    ds_read_b128 v[128:131], v2 offset:3968
    ds_read_b64 v[144:145], v3 offset:384
    ds_read_b64 v[146:147], v3 offset:392
    ds_read_b128 v[132:135], v2 offset:3456
    ds_read_b64 v[148:149], v3 offset:896
    ds_read_b64 v[150:151], v3 offset:904
    ds_read_b128 v[136:139], v2 offset:2944
    ds_read_b64 v[152:153], v3 offset:1408
    ds_read_b64 v[154:155], v3 offset:1416
    ds_read_b128 v[140:143], v2 offset:2432
    ds_read_b64 v[156:157], v3 offset:1920
    ds_read_b64 v[158:159], v3 offset:1928
    s_waitcnt lgkmcnt(12)
    v_mfma_f32_16x16x32_bf16 v[32:35], v[96:99], v[112:115], 0
    ds_read_b128 v[160:163], v2 offset:3904
    ds_read_b64 v[176:177], v3 offset:320
    v_mfma_f32_16x16x32_bf16 v[40:43], v[96:99], v[120:123], 0
    ds_read_b64 v[178:179], v3 offset:328
    ds_read_b128 v[164:167], v2 offset:3392
    v_mfma_f32_16x16x32_bf16 v[44:47], v[96:99], v[124:127], 0
    ds_read_b64 v[180:181], v3 offset:832
    ds_read_b64 v[182:183], v3 offset:840
    v_mfma_f32_16x16x32_bf16 v[40:43], v[100:103], v[116:119], v[40:43]
    ds_read_b128 v[168:171], v2 offset:2880
    ds_read_b64 v[184:185], v3 offset:1344
    v_mfma_f32_16x16x32_bf16 v[44:47], v[100:103], v[120:123], v[44:47]
    ds_read_b64 v[186:187], v3 offset:1352
    ds_read_b128 v[172:175], v2 offset:2368
    v_mfma_f32_16x16x32_bf16 v[40:43], v[104:107], v[112:115], v[40:43]
    ds_read_b64 v[188:189], v3 offset:1856
    ds_read_b64 v[190:191], v3 offset:1864
    v_mfma_f32_16x16x32_bf16 v[44:47], v[104:107], v[116:119], v[44:47]
    v_mfma_f32_16x16x32_bf16 v[44:47], v[108:111], v[112:115], v[44:47]
    s_waitcnt lgkmcnt(12)
    v_mfma_f32_16x16x32_bf16 v[32:35], v[128:131], v[144:147], v[32:35]
    ds_read_b128 v[96:99], v2 offset:3840
    ds_read_b64 v[112:113], v3 offset:256
    v_mfma_f32_16x16x32_bf16 v[40:43], v[128:131], v[152:155], v[40:43]
    ds_read_b64 v[114:115], v3 offset:264
    ds_read_b128 v[100:103], v2 offset:3328
    v_mfma_f32_16x16x32_bf16 v[44:47], v[128:131], v[156:159], v[44:47]
    ds_read_b64 v[116:117], v3 offset:768
    ds_read_b64 v[118:119], v3 offset:776
    v_mfma_f32_16x16x32_bf16 v[40:43], v[132:135], v[148:151], v[40:43]
    ds_read_b128 v[104:107], v2 offset:2816
    ds_read_b64 v[120:121], v3 offset:1280
    v_mfma_f32_16x16x32_bf16 v[44:47], v[132:135], v[152:155], v[44:47]
    ds_read_b64 v[122:123], v3 offset:1288
    ds_read_b128 v[108:111], v2 offset:2304
    v_mfma_f32_16x16x32_bf16 v[40:43], v[136:139], v[144:147], v[40:43]
    ds_read_b64 v[124:125], v3 offset:1792
    ds_read_b64 v[126:127], v3 offset:1800
    v_mfma_f32_16x16x32_bf16 v[44:47], v[136:139], v[148:151], v[44:47]
    v_mfma_f32_16x16x32_bf16 v[44:47], v[140:143], v[144:147], v[44:47]
    s_waitcnt lgkmcnt(12)
    v_mfma_f32_16x16x32_bf16 v[32:35], v[160:163], v[176:179], v[32:35]
    ds_read_b128 v[128:131], v2 offset:3776
    ds_read_b64 v[144:145], v3 offset:192
    v_mfma_f32_16x16x32_bf16 v[40:43], v[160:163], v[184:187], v[40:43]
    ds_read_b64 v[146:147], v3 offset:200
    ds_read_b128 v[132:135], v2 offset:3264
    v_mfma_f32_16x16x32_bf16 v[44:47], v[160:163], v[188:191], v[44:47]
    ds_read_b64 v[148:149], v3 offset:704
    ds_read_b64 v[150:151], v3 offset:712
    v_mfma_f32_16x16x32_bf16 v[40:43], v[164:167], v[180:183], v[40:43]
    ds_read_b128 v[136:139], v2 offset:2752
    ds_read_b64 v[152:153], v3 offset:1216
    v_mfma_f32_16x16x32_bf16 v[44:47], v[164:167], v[184:187], v[44:47]
    ds_read_b64 v[154:155], v3 offset:1224
    ds_read_b128 v[140:143], v2 offset:2240
    v_mfma_f32_16x16x32_bf16 v[40:43], v[168:171], v[176:179], v[40:43]
    ds_read_b64 v[156:157], v3 offset:1728
    ds_read_b64 v[158:159], v3 offset:1736
    v_mfma_f32_16x16x32_bf16 v[44:47], v[168:171], v[180:183], v[44:47]
    v_mfma_f32_16x16x32_bf16 v[44:47], v[172:175], v[176:179], v[44:47]
    s_waitcnt lgkmcnt(12)
    v_mfma_f32_16x16x32_bf16 v[32:35], v[96:99], v[112:115], v[32:35]
    ds_read_b128 v[160:163], v2 offset:3712
    ds_read_b64 v[176:177], v3 offset:128
    v_mfma_f32_16x16x32_bf16 v[40:43], v[96:99], v[120:123], v[40:43]
    ds_read_b64 v[178:179], v3 offset:136
    ds_read_b128 v[164:167], v2 offset:3200
    v_mfma_f32_16x16x32_bf16 v[44:47], v[96:99], v[124:127], v[44:47]
    ds_read_b64 v[180:181], v3 offset:640
    ds_read_b64 v[182:183], v3 offset:648
    v_mfma_f32_16x16x32_bf16 v[40:43], v[100:103], v[116:119], v[40:43]
    ds_read_b128 v[168:171], v2 offset:2688
    ds_read_b64 v[184:185], v3 offset:1152
    v_mfma_f32_16x16x32_bf16 v[44:47], v[100:103], v[120:123], v[44:47]
    ds_read_b64 v[186:187], v3 offset:1160
    ds_read_b128 v[172:175], v2 offset:2176
    v_mfma_f32_16x16x32_bf16 v[40:43], v[104:107], v[112:115], v[40:43]
    ds_read_b64 v[188:189], v3 offset:1664
    ds_read_b64 v[190:191], v3 offset:1672
    v_mfma_f32_16x16x32_bf16 v[44:47], v[104:107], v[116:119], v[44:47]
    v_mfma_f32_16x16x32_bf16 v[44:47], v[108:111], v[112:115], v[44:47]
    s_waitcnt lgkmcnt(12)
    v_mfma_f32_16x16x32_bf16 v[32:35], v[128:131], v[144:147], v[32:35]
    ds_read_b128 v[96:99], v2 offset:3648
    ds_read_b64 v[112:113], v3 offset:64
    v_mfma_f32_16x16x32_bf16 v[40:43], v[128:131], v[152:155], v[40:43]
    ds_read_b64 v[114:115], v3 offset:72
    ds_read_b128 v[100:103], v2 offset:3136
    v_mfma_f32_16x16x32_bf16 v[44:47], v[128:131], v[156:159], v[44:47]
    ds_read_b64 v[116:117], v3 offset:576
    ds_read_b64 v[118:119], v3 offset:584
    v_mfma_f32_16x16x32_bf16 v[40:43], v[132:135], v[148:151], v[40:43]
    ds_read_b128 v[104:107], v2 offset:2624
    ds_read_b64 v[120:121], v3 offset:1088
    v_mfma_f32_16x16x32_bf16 v[44:47], v[132:135], v[152:155], v[44:47]
    ds_read_b64 v[122:123], v3 offset:1096
    ds_read_b128 v[108:111], v2 offset:2112
    v_mfma_f32_16x16x32_bf16 v[40:43], v[136:139], v[144:147], v[40:43]
    ds_read_b64 v[124:125], v3 offset:1600
    ds_read_b64 v[126:127], v3 offset:1608
    v_mfma_f32_16x16x32_bf16 v[44:47], v[136:139], v[148:151], v[44:47]
    v_mfma_f32_16x16x32_bf16 v[44:47], v[140:143], v[144:147], v[44:47]
    s_waitcnt lgkmcnt(12)
    v_mfma_f32_16x16x32_bf16 v[32:35], v[160:163], v[176:179], v[32:35]
    ds_read_b128 v[128:131], v2 offset:3584
    ds_read_b64 v[144:145], v3 offset:0
    v_mfma_f32_16x16x32_bf16 v[40:43], v[160:163], v[184:187], v[40:43]
    ds_read_b64 v[146:147], v3 offset:8
    ds_read_b128 v[132:135], v2 offset:3072
    v_mfma_f32_16x16x32_bf16 v[44:47], v[160:163], v[188:191], v[44:47]
    ds_read_b64 v[148:149], v3 offset:512
    ds_read_b64 v[150:151], v3 offset:520
    v_mfma_f32_16x16x32_bf16 v[40:43], v[164:167], v[180:183], v[40:43]
    ds_read_b128 v[136:139], v2 offset:2560
    ds_read_b64 v[152:153], v3 offset:1024
    v_mfma_f32_16x16x32_bf16 v[44:47], v[164:167], v[184:187], v[44:47]
    ds_read_b64 v[154:155], v3 offset:1032
    ds_read_b128 v[140:143], v2 offset:2048
    v_mfma_f32_16x16x32_bf16 v[40:43], v[168:171], v[176:179], v[40:43]
    ds_read_b64 v[156:157], v3 offset:1536
    ds_read_b64 v[158:159], v3 offset:1544
    v_mfma_f32_16x16x32_bf16 v[44:47], v[168:171], v[180:183], v[44:47]
    v_mfma_f32_16x16x32_bf16 v[44:47], v[172:175], v[176:179], v[44:47]
    s_waitcnt lgkmcnt(12)
    v_mfma_f32_16x16x32_bf16 v[32:35], v[96:99], v[112:115], v[32:35]
    ds_read_b128 v[160:163], v2 offset:21696
    ds_read_b64 v[176:177], v3 offset:18112
    v_mfma_f32_16x16x32_bf16 v[40:43], v[96:99], v[120:123], v[40:43]
    ds_read_b64 v[178:179], v3 offset:18120
    ds_read_b128 v[164:167], v2 offset:21184
    v_mfma_f32_16x16x32_bf16 v[44:47], v[96:99], v[124:127], v[44:47]
    ds_read_b64 v[180:181], v3 offset:18624
    ds_read_b64 v[182:183], v3 offset:18632
    v_mfma_f32_16x16x32_bf16 v[40:43], v[100:103], v[116:119], v[40:43]
    ds_read_b128 v[168:171], v2 offset:20672
    ds_read_b64 v[184:185], v3 offset:19136
    v_mfma_f32_16x16x32_bf16 v[44:47], v[100:103], v[120:123], v[44:47]
    ds_read_b64 v[186:187], v3 offset:19144
    ds_read_b128 v[172:175], v2 offset:20160
    v_mfma_f32_16x16x32_bf16 v[40:43], v[104:107], v[112:115], v[40:43]
    ds_read_b64 v[188:189], v3 offset:19648
    ds_read_b64 v[190:191], v3 offset:19656
    v_mfma_f32_16x16x32_bf16 v[44:47], v[104:107], v[116:119], v[44:47]
    v_mfma_f32_16x16x32_bf16 v[44:47], v[108:111], v[112:115], v[44:47]
    s_waitcnt lgkmcnt(12)
    v_mfma_f32_16x16x32_bf16 v[32:35], v[128:131], v[144:147], v[32:35]
    ds_read_b128 v[96:99], v2 offset:21632
    ds_read_b64 v[112:113], v3 offset:18048
    v_mfma_f32_16x16x32_bf16 v[40:43], v[128:131], v[152:155], v[40:43]
    ds_read_b64 v[114:115], v3 offset:18056
    ds_read_b128 v[100:103], v2 offset:21120
    v_mfma_f32_16x16x32_bf16 v[44:47], v[128:131], v[156:159], v[44:47]
    ds_read_b64 v[116:117], v3 offset:18560
    ds_read_b64 v[118:119], v3 offset:18568
    v_mfma_f32_16x16x32_bf16 v[40:43], v[132:135], v[148:151], v[40:43]
    ds_read_b128 v[104:107], v2 offset:20608
    ds_read_b64 v[120:121], v3 offset:19072
    v_mfma_f32_16x16x32_bf16 v[44:47], v[132:135], v[152:155], v[44:47]
    ds_read_b64 v[122:123], v3 offset:19080
    ds_read_b128 v[108:111], v2 offset:20096
    v_mfma_f32_16x16x32_bf16 v[40:43], v[136:139], v[144:147], v[40:43]
    ds_read_b64 v[124:125], v3 offset:19584
    ds_read_b64 v[126:127], v3 offset:19592
    v_mfma_f32_16x16x32_bf16 v[44:47], v[136:139], v[148:151], v[44:47]
    v_mfma_f32_16x16x32_bf16 v[44:47], v[140:143], v[144:147], v[44:47]
    s_waitcnt lgkmcnt(12)
    v_mfma_f32_16x16x32_bf16 v[48:51], v[160:163], v[176:179], 0
    ds_read_b128 v[128:131], v2 offset:21568
    ds_read_b64 v[144:145], v3 offset:17984
    v_mfma_f32_16x16x32_bf16 v[56:59], v[160:163], v[184:187], 0
    ds_read_b64 v[146:147], v3 offset:17992
    ds_read_b128 v[132:135], v2 offset:21056
    v_mfma_f32_16x16x32_bf16 v[60:63], v[160:163], v[188:191], 0
    ds_read_b64 v[148:149], v3 offset:18496
    ds_read_b64 v[150:151], v3 offset:18504
    v_mfma_f32_16x16x32_bf16 v[56:59], v[164:167], v[180:183], v[56:59]
    ds_read_b128 v[136:139], v2 offset:20544
    ds_read_b64 v[152:153], v3 offset:19008
    v_mfma_f32_16x16x32_bf16 v[60:63], v[164:167], v[184:187], v[60:63]
    ds_read_b64 v[154:155], v3 offset:19016
    ds_read_b128 v[140:143], v2 offset:20032
    v_mfma_f32_16x16x32_bf16 v[56:59], v[168:171], v[176:179], v[56:59]
    ds_read_b64 v[156:157], v3 offset:19520
    ds_read_b64 v[158:159], v3 offset:19528
    v_mfma_f32_16x16x32_bf16 v[60:63], v[168:171], v[180:183], v[60:63]
    v_mfma_f32_16x16x32_bf16 v[60:63], v[172:175], v[176:179], v[60:63]
    s_waitcnt lgkmcnt(12)
    v_mfma_f32_16x16x32_bf16 v[48:51], v[96:99], v[112:115], v[48:51]
    ds_read_b128 v[160:163], v2 offset:21504
    ds_read_b64 v[176:177], v3 offset:17920
    v_mfma_f32_16x16x32_bf16 v[56:59], v[96:99], v[120:123], v[56:59]
    ds_read_b64 v[178:179], v3 offset:17928
    ds_read_b128 v[164:167], v2 offset:20992
    v_mfma_f32_16x16x32_bf16 v[60:63], v[96:99], v[124:127], v[60:63]
    ds_read_b64 v[180:181], v3 offset:18432
    ds_read_b64 v[182:183], v3 offset:18440
    v_mfma_f32_16x16x32_bf16 v[56:59], v[100:103], v[116:119], v[56:59]
    ds_read_b128 v[168:171], v2 offset:20480
    ds_read_b64 v[184:185], v3 offset:18944
    v_mfma_f32_16x16x32_bf16 v[60:63], v[100:103], v[120:123], v[60:63]
    ds_read_b64 v[186:187], v3 offset:18952
    ds_read_b128 v[172:175], v2 offset:19968
    v_mfma_f32_16x16x32_bf16 v[56:59], v[104:107], v[112:115], v[56:59]
    ds_read_b64 v[188:189], v3 offset:19456
    ds_read_b64 v[190:191], v3 offset:19464
    v_mfma_f32_16x16x32_bf16 v[60:63], v[104:107], v[116:119], v[60:63]
    v_cvt_pk_bf16_f32 v64, v32, v33
    v_cvt_pk_bf16_f32 v65, v34, v35
    v_mfma_f32_16x16x32_bf16 v[60:63], v[108:111], v[112:115], v[60:63]
    buffer_store_dwordx2 v[64:65], v4, s[48:51], s64 offen offset:0 sc1
    v_cvt_pk_bf16_f32 v68, v40, v41
    v_cvt_pk_bf16_f32 v69, v42, v43
    buffer_store_dwordx2 v[68:69], v4, s[48:51], s64 offen offset:1024 sc1
    v_cvt_pk_bf16_f32 v70, v44, v45
    v_cvt_pk_bf16_f32 v71, v46, v47
    buffer_store_dwordx2 v[70:71], v4, s[48:51], s64 offen offset:1536 sc1
    s_add_u32 s64, s64, 4096
    s_waitcnt lgkmcnt(12)
    v_mfma_f32_16x16x32_bf16 v[48:51], v[128:131], v[144:147], v[48:51]
    ds_read_b128 v[96:99], v2 offset:21440
    ds_read_b64 v[112:113], v3 offset:17856
    v_mfma_f32_16x16x32_bf16 v[56:59], v[128:131], v[152:155], v[56:59]
    ds_read_b64 v[114:115], v3 offset:17864
    ds_read_b128 v[100:103], v2 offset:20928
    v_mfma_f32_16x16x32_bf16 v[60:63], v[128:131], v[156:159], v[60:63]
    ds_read_b64 v[116:117], v3 offset:18368
    ds_read_b64 v[118:119], v3 offset:18376
    v_mfma_f32_16x16x32_bf16 v[56:59], v[132:135], v[148:151], v[56:59]
    ds_read_b128 v[104:107], v2 offset:20416
    ds_read_b64 v[120:121], v3 offset:18880
    v_mfma_f32_16x16x32_bf16 v[60:63], v[132:135], v[152:155], v[60:63]
    ds_read_b64 v[122:123], v3 offset:18888
    ds_read_b128 v[108:111], v2 offset:19904
    v_mfma_f32_16x16x32_bf16 v[56:59], v[136:139], v[144:147], v[56:59]
    ds_read_b64 v[124:125], v3 offset:19392
    ds_read_b64 v[126:127], v3 offset:19400
    v_mfma_f32_16x16x32_bf16 v[60:63], v[136:139], v[148:151], v[60:63]
    v_mfma_f32_16x16x32_bf16 v[60:63], v[140:143], v[144:147], v[60:63]
    s_waitcnt lgkmcnt(12)
    v_mfma_f32_16x16x32_bf16 v[48:51], v[160:163], v[176:179], v[48:51]
    ds_read_b128 v[128:131], v2 offset:21376
    ds_read_b64 v[144:145], v3 offset:17792
    v_mfma_f32_16x16x32_bf16 v[56:59], v[160:163], v[184:187], v[56:59]
    ds_read_b64 v[146:147], v3 offset:17800
    ds_read_b128 v[132:135], v2 offset:20864
    v_mfma_f32_16x16x32_bf16 v[60:63], v[160:163], v[188:191], v[60:63]
    ds_read_b64 v[148:149], v3 offset:18304
    ds_read_b64 v[150:151], v3 offset:18312
    v_mfma_f32_16x16x32_bf16 v[56:59], v[164:167], v[180:183], v[56:59]
    ds_read_b128 v[136:139], v2 offset:20352
    ds_read_b64 v[152:153], v3 offset:18816
    v_mfma_f32_16x16x32_bf16 v[60:63], v[164:167], v[184:187], v[60:63]
    ds_read_b64 v[154:155], v3 offset:18824
    ds_read_b128 v[140:143], v2 offset:19840
    v_mfma_f32_16x16x32_bf16 v[56:59], v[168:171], v[176:179], v[56:59]
    ds_read_b64 v[156:157], v3 offset:19328
    ds_read_b64 v[158:159], v3 offset:19336
    v_mfma_f32_16x16x32_bf16 v[60:63], v[168:171], v[180:183], v[60:63]
    v_mfma_f32_16x16x32_bf16 v[60:63], v[172:175], v[176:179], v[60:63]
    s_waitcnt lgkmcnt(12)
    v_mfma_f32_16x16x32_bf16 v[48:51], v[96:99], v[112:115], v[48:51]
    ds_read_b128 v[160:163], v2 offset:21312
    ds_read_b64 v[176:177], v3 offset:17728
    v_mfma_f32_16x16x32_bf16 v[56:59], v[96:99], v[120:123], v[56:59]
    ds_read_b64 v[178:179], v3 offset:17736
    ds_read_b128 v[164:167], v2 offset:20800
    v_mfma_f32_16x16x32_bf16 v[60:63], v[96:99], v[124:127], v[60:63]
    ds_read_b64 v[180:181], v3 offset:18240
    ds_read_b64 v[182:183], v3 offset:18248
    v_mfma_f32_16x16x32_bf16 v[56:59], v[100:103], v[116:119], v[56:59]
    ds_read_b128 v[168:171], v2 offset:20288
    ds_read_b64 v[184:185], v3 offset:18752
    v_mfma_f32_16x16x32_bf16 v[60:63], v[100:103], v[120:123], v[60:63]
    ds_read_b64 v[186:187], v3 offset:18760
    ds_read_b128 v[172:175], v2 offset:19776
    v_mfma_f32_16x16x32_bf16 v[56:59], v[104:107], v[112:115], v[56:59]
    ds_read_b64 v[188:189], v3 offset:19264
    ds_read_b64 v[190:191], v3 offset:19272
    v_mfma_f32_16x16x32_bf16 v[60:63], v[104:107], v[116:119], v[60:63]
    v_mfma_f32_16x16x32_bf16 v[60:63], v[108:111], v[112:115], v[60:63]
    s_waitcnt lgkmcnt(12)
    v_mfma_f32_16x16x32_bf16 v[48:51], v[128:131], v[144:147], v[48:51]
    ds_read_b128 v[96:99], v2 offset:21248
    ds_read_b64 v[112:113], v3 offset:17664
    v_mfma_f32_16x16x32_bf16 v[56:59], v[128:131], v[152:155], v[56:59]
    ds_read_b64 v[114:115], v3 offset:17672
    ds_read_b128 v[100:103], v2 offset:20736
    v_mfma_f32_16x16x32_bf16 v[60:63], v[128:131], v[156:159], v[60:63]
    ds_read_b64 v[116:117], v3 offset:18176
    ds_read_b64 v[118:119], v3 offset:18184
    v_mfma_f32_16x16x32_bf16 v[56:59], v[132:135], v[148:151], v[56:59]
    ds_read_b128 v[104:107], v2 offset:20224
    ds_read_b64 v[120:121], v3 offset:18688
    v_mfma_f32_16x16x32_bf16 v[60:63], v[132:135], v[152:155], v[60:63]
    ds_read_b64 v[122:123], v3 offset:18696
    ds_read_b128 v[108:111], v2 offset:19712
    v_mfma_f32_16x16x32_bf16 v[56:59], v[136:139], v[144:147], v[56:59]
    ds_read_b64 v[124:125], v3 offset:19200
    ds_read_b64 v[126:127], v3 offset:19208
    v_mfma_f32_16x16x32_bf16 v[60:63], v[136:139], v[148:151], v[60:63]
    v_mfma_f32_16x16x32_bf16 v[60:63], v[140:143], v[144:147], v[60:63]
    s_waitcnt lgkmcnt(12)
    v_mfma_f32_16x16x32_bf16 v[48:51], v[160:163], v[176:179], v[48:51]
    ds_read_b128 v[128:131], v2 offset:39360
    ds_read_b64 v[144:145], v3 offset:35776
    v_mfma_f32_16x16x32_bf16 v[56:59], v[160:163], v[184:187], v[56:59]
    ds_read_b64 v[146:147], v3 offset:35784
    ds_read_b128 v[132:135], v2 offset:38848
    v_mfma_f32_16x16x32_bf16 v[60:63], v[160:163], v[188:191], v[60:63]
    ds_read_b64 v[148:149], v3 offset:36288
    ds_read_b64 v[150:151], v3 offset:36296
    v_mfma_f32_16x16x32_bf16 v[56:59], v[164:167], v[180:183], v[56:59]
    ds_read_b128 v[136:139], v2 offset:38336
    ds_read_b64 v[152:153], v3 offset:36800
    v_mfma_f32_16x16x32_bf16 v[60:63], v[164:167], v[184:187], v[60:63]
    ds_read_b64 v[154:155], v3 offset:36808
    ds_read_b128 v[140:143], v2 offset:37824
    v_mfma_f32_16x16x32_bf16 v[56:59], v[168:171], v[176:179], v[56:59]
    ds_read_b64 v[156:157], v3 offset:37312
    ds_read_b64 v[158:159], v3 offset:37320
    v_mfma_f32_16x16x32_bf16 v[60:63], v[168:171], v[180:183], v[60:63]
    v_mfma_f32_16x16x32_bf16 v[60:63], v[172:175], v[176:179], v[60:63]
    s_waitcnt lgkmcnt(12)
    v_mfma_f32_16x16x32_bf16 v[48:51], v[96:99], v[112:115], v[48:51]
    ds_read_b128 v[160:163], v2 offset:39296
    ds_read_b64 v[176:177], v3 offset:35712
    v_mfma_f32_16x16x32_bf16 v[56:59], v[96:99], v[120:123], v[56:59]
    ds_read_b64 v[178:179], v3 offset:35720
    ds_read_b128 v[164:167], v2 offset:38784
    v_mfma_f32_16x16x32_bf16 v[60:63], v[96:99], v[124:127], v[60:63]
    ds_read_b64 v[180:181], v3 offset:36224
    ds_read_b64 v[182:183], v3 offset:36232
    v_mfma_f32_16x16x32_bf16 v[56:59], v[100:103], v[116:119], v[56:59]
    ds_read_b128 v[168:171], v2 offset:38272
    ds_read_b64 v[184:185], v3 offset:36736
    v_mfma_f32_16x16x32_bf16 v[60:63], v[100:103], v[120:123], v[60:63]
    ds_read_b64 v[186:187], v3 offset:36744
    ds_read_b128 v[172:175], v2 offset:37760
    v_mfma_f32_16x16x32_bf16 v[56:59], v[104:107], v[112:115], v[56:59]
    ds_read_b64 v[188:189], v3 offset:37248
    ds_read_b64 v[190:191], v3 offset:37256
    v_mfma_f32_16x16x32_bf16 v[60:63], v[104:107], v[116:119], v[60:63]
    v_mfma_f32_16x16x32_bf16 v[60:63], v[108:111], v[112:115], v[60:63]
    s_cmp_lt_u32 s61, 3
    s_cbranch_scc1 L_m2
    s_waitcnt lgkmcnt(12)
    v_mfma_f32_16x16x32_bf16 v[32:35], v[128:131], v[144:147], 0
    ds_read_b128 v[96:99], v2 offset:39232
    ds_read_b64 v[112:113], v3 offset:35648
    v_mfma_f32_16x16x32_bf16 v[40:43], v[128:131], v[152:155], 0
    ds_read_b64 v[114:115], v3 offset:35656
    ds_read_b128 v[100:103], v2 offset:38720
    v_mfma_f32_16x16x32_bf16 v[44:47], v[128:131], v[156:159], 0
    ds_read_b64 v[116:117], v3 offset:36160
    ds_read_b64 v[118:119], v3 offset:36168
    v_mfma_f32_16x16x32_bf16 v[40:43], v[132:135], v[148:151], v[40:43]
    ds_read_b128 v[104:107], v2 offset:38208
    ds_read_b64 v[120:121], v3 offset:36672
    v_mfma_f32_16x16x32_bf16 v[44:47], v[132:135], v[152:155], v[44:47]
    ds_read_b64 v[122:123], v3 offset:36680
    ds_read_b128 v[108:111], v2 offset:37696
    v_mfma_f32_16x16x32_bf16 v[40:43], v[136:139], v[144:147], v[40:43]
    ds_read_b64 v[124:125], v3 offset:37184
    ds_read_b64 v[126:127], v3 offset:37192
    v_mfma_f32_16x16x32_bf16 v[44:47], v[136:139], v[148:151], v[44:47]
    v_mfma_f32_16x16x32_bf16 v[44:47], v[140:143], v[144:147], v[44:47]
    s_waitcnt lgkmcnt(12)
    v_mfma_f32_16x16x32_bf16 v[32:35], v[160:163], v[176:179], v[32:35]
    ds_read_b128 v[128:131], v2 offset:39168
    ds_read_b64 v[144:145], v3 offset:35584
    v_mfma_f32_16x16x32_bf16 v[40:43], v[160:163], v[184:187], v[40:43]
    ds_read_b64 v[146:147], v3 offset:35592
    ds_read_b128 v[132:135], v2 offset:38656
    v_mfma_f32_16x16x32_bf16 v[44:47], v[160:163], v[188:191], v[44:47]
    ds_read_b64 v[148:149], v3 offset:36096
    ds_read_b64 v[150:151], v3 offset:36104
    v_mfma_f32_16x16x32_bf16 v[40:43], v[164:167], v[180:183], v[40:43]
    ds_read_b128 v[136:139], v2 offset:38144
    ds_read_b64 v[152:153], v3 offset:36608
    v_mfma_f32_16x16x32_bf16 v[44:47], v[164:167], v[184:187], v[44:47]
    ds_read_b64 v[154:155], v3 offset:36616
    ds_read_b128 v[140:143], v2 offset:37632
    v_mfma_f32_16x16x32_bf16 v[40:43], v[168:171], v[176:179], v[40:43]
    ds_read_b64 v[156:157], v3 offset:37120
    ds_read_b64 v[158:159], v3 offset:37128
    v_mfma_f32_16x16x32_bf16 v[44:47], v[168:171], v[180:183], v[44:47]
    v_cvt_pk_bf16_f32 v72, v48, v49
    v_cvt_pk_bf16_f32 v73, v50, v51
    v_mfma_f32_16x16x32_bf16 v[44:47], v[172:175], v[176:179], v[44:47]
    buffer_store_dwordx2 v[72:73], v4, s[48:51], s64 offen offset:0 sc1
    v_cvt_pk_bf16_f32 v76, v56, v57
    v_cvt_pk_bf16_f32 v77, v58, v59
    buffer_store_dwordx2 v[76:77], v4, s[48:51], s64 offen offset:1024 sc1
    v_cvt_pk_bf16_f32 v78, v60, v61
    v_cvt_pk_bf16_f32 v79, v62, v63
    buffer_store_dwordx2 v[78:79], v4, s[48:51], s64 offen offset:1536 sc1
    s_add_u32 s64, s64, 4096
    s_waitcnt lgkmcnt(12)
    v_mfma_f32_16x16x32_bf16 v[32:35], v[96:99], v[112:115], v[32:35]
    ds_read_b128 v[160:163], v2 offset:39104
    ds_read_b64 v[176:177], v3 offset:35520
    v_mfma_f32_16x16x32_bf16 v[40:43], v[96:99], v[120:123], v[40:43]
    ds_read_b64 v[178:179], v3 offset:35528
    ds_read_b128 v[164:167], v2 offset:38592
    v_mfma_f32_16x16x32_bf16 v[44:47], v[96:99], v[124:127], v[44:47]
    ds_read_b64 v[180:181], v3 offset:36032
    ds_read_b64 v[182:183], v3 offset:36040
    v_mfma_f32_16x16x32_bf16 v[40:43], v[100:103], v[116:119], v[40:43]
    ds_read_b128 v[168:171], v2 offset:38080
    ds_read_b64 v[184:185], v3 offset:36544
    v_mfma_f32_16x16x32_bf16 v[44:47], v[100:103], v[120:123], v[44:47]
    ds_read_b64 v[186:187], v3 offset:36552
    ds_read_b128 v[172:175], v2 offset:37568
    v_mfma_f32_16x16x32_bf16 v[40:43], v[104:107], v[112:115], v[40:43]
    ds_read_b64 v[188:189], v3 offset:37056
    ds_read_b64 v[190:191], v3 offset:37064
    v_mfma_f32_16x16x32_bf16 v[44:47], v[104:107], v[116:119], v[44:47]
    v_mfma_f32_16x16x32_bf16 v[44:47], v[108:111], v[112:115], v[44:47]
    s_waitcnt lgkmcnt(12)
    v_mfma_f32_16x16x32_bf16 v[32:35], v[128:131], v[144:147], v[32:35]
    ds_read_b128 v[96:99], v2 offset:39040
    ds_read_b64 v[112:113], v3 offset:35456
    v_mfma_f32_16x16x32_bf16 v[40:43], v[128:131], v[152:155], v[40:43]
    ds_read_b64 v[114:115], v3 offset:35464
    ds_read_b128 v[100:103], v2 offset:38528
    v_mfma_f32_16x16x32_bf16 v[44:47], v[128:131], v[156:159], v[44:47]
    ds_read_b64 v[116:117], v3 offset:35968
    ds_read_b64 v[118:119], v3 offset:35976
    v_mfma_f32_16x16x32_bf16 v[40:43], v[132:135], v[148:151], v[40:43]
    ds_read_b128 v[104:107], v2 offset:38016
    ds_read_b64 v[120:121], v3 offset:36480
    v_mfma_f32_16x16x32_bf16 v[44:47], v[132:135], v[152:155], v[44:47]
    ds_read_b64 v[122:123], v3 offset:36488
    ds_read_b128 v[108:111], v2 offset:37504
    v_mfma_f32_16x16x32_bf16 v[40:43], v[136:139], v[144:147], v[40:43]
    ds_read_b64 v[124:125], v3 offset:36992
    ds_read_b64 v[126:127], v3 offset:37000
    v_mfma_f32_16x16x32_bf16 v[44:47], v[136:139], v[148:151], v[44:47]
    v_mfma_f32_16x16x32_bf16 v[44:47], v[140:143], v[144:147], v[44:47]
    s_waitcnt lgkmcnt(12)
    v_mfma_f32_16x16x32_bf16 v[32:35], v[160:163], v[176:179], v[32:35]
    ds_read_b128 v[128:131], v2 offset:38976
    ds_read_b64 v[144:145], v3 offset:35392
    v_mfma_f32_16x16x32_bf16 v[40:43], v[160:163], v[184:187], v[40:43]
    ds_read_b64 v[146:147], v3 offset:35400
    ds_read_b128 v[132:135], v2 offset:38464
    v_mfma_f32_16x16x32_bf16 v[44:47], v[160:163], v[188:191], v[44:47]
    ds_read_b64 v[148:149], v3 offset:35904
    ds_read_b64 v[150:151], v3 offset:35912
    v_mfma_f32_16x16x32_bf16 v[40:43], v[164:167], v[180:183], v[40:43]
    ds_read_b128 v[136:139], v2 offset:37952
    ds_read_b64 v[152:153], v3 offset:36416
    v_mfma_f32_16x16x32_bf16 v[44:47], v[164:167], v[184:187], v[44:47]
    ds_read_b64 v[154:155], v3 offset:36424
    ds_read_b128 v[140:143], v2 offset:37440
    v_mfma_f32_16x16x32_bf16 v[40:43], v[168:171], v[176:179], v[40:43]
    ds_read_b64 v[156:157], v3 offset:36928
    ds_read_b64 v[158:159], v3 offset:36936
    v_mfma_f32_16x16x32_bf16 v[44:47], v[168:171], v[180:183], v[44:47]
    v_mfma_f32_16x16x32_bf16 v[44:47], v[172:175], v[176:179], v[44:47]
    s_waitcnt lgkmcnt(12)
    v_mfma_f32_16x16x32_bf16 v[32:35], v[96:99], v[112:115], v[32:35]
    ds_read_b128 v[160:163], v2 offset:38912
    ds_read_b64 v[176:177], v3 offset:35328
    v_mfma_f32_16x16x32_bf16 v[40:43], v[96:99], v[120:123], v[40:43]
    ds_read_b64 v[178:179], v3 offset:35336
    ds_read_b128 v[164:167], v2 offset:38400
    v_mfma_f32_16x16x32_bf16 v[44:47], v[96:99], v[124:127], v[44:47]
    ds_read_b64 v[180:181], v3 offset:35840
    ds_read_b64 v[182:183], v3 offset:35848
    v_mfma_f32_16x16x32_bf16 v[40:43], v[100:103], v[116:119], v[40:43]
    ds_read_b128 v[168:171], v2 offset:37888
    ds_read_b64 v[184:185], v3 offset:36352
    v_mfma_f32_16x16x32_bf16 v[44:47], v[100:103], v[120:123], v[44:47]
    ds_read_b64 v[186:187], v3 offset:36360
    ds_read_b128 v[172:175], v2 offset:37376
    v_mfma_f32_16x16x32_bf16 v[40:43], v[104:107], v[112:115], v[40:43]
    ds_read_b64 v[188:189], v3 offset:36864
    ds_read_b64 v[190:191], v3 offset:36872
    v_mfma_f32_16x16x32_bf16 v[44:47], v[104:107], v[116:119], v[44:47]
    v_mfma_f32_16x16x32_bf16 v[44:47], v[108:111], v[112:115], v[44:47]
    s_waitcnt lgkmcnt(12)
    v_mfma_f32_16x16x32_bf16 v[32:35], v[128:131], v[144:147], v[32:35]
    v_mfma_f32_16x16x32_bf16 v[40:43], v[128:131], v[152:155], v[40:43]
    v_mfma_f32_16x16x32_bf16 v[44:47], v[128:131], v[156:159], v[44:47]
    v_mfma_f32_16x16x32_bf16 v[40:43], v[132:135], v[148:151], v[40:43]
    v_mfma_f32_16x16x32_bf16 v[44:47], v[132:135], v[152:155], v[44:47]
    v_mfma_f32_16x16x32_bf16 v[40:43], v[136:139], v[144:147], v[40:43]
    v_mfma_f32_16x16x32_bf16 v[44:47], v[136:139], v[148:151], v[44:47]
    v_mfma_f32_16x16x32_bf16 v[44:47], v[140:143], v[144:147], v[44:47]
    s_waitcnt lgkmcnt(0)
    v_mfma_f32_16x16x32_bf16 v[32:35], v[160:163], v[176:179], v[32:35]
    v_mfma_f32_16x16x32_bf16 v[40:43], v[160:163], v[184:187], v[40:43]
    v_mfma_f32_16x16x32_bf16 v[44:47], v[160:163], v[188:191], v[44:47]
    v_mfma_f32_16x16x32_bf16 v[40:43], v[164:167], v[180:183], v[40:43]
    v_mfma_f32_16x16x32_bf16 v[44:47], v[164:167], v[184:187], v[44:47]
    v_mfma_f32_16x16x32_bf16 v[40:43], v[168:171], v[176:179], v[40:43]
    v_mfma_f32_16x16x32_bf16 v[44:47], v[168:171], v[180:183], v[44:47]
    v_mfma_f32_16x16x32_bf16 v[44:47], v[172:175], v[176:179], v[44:47]
    s_setprio 3
    v_cvt_pk_bf16_f32 v80, v32, v33
    v_cvt_pk_bf16_f32 v81, v34, v35
    buffer_store_dwordx2 v[80:81], v4, s[48:51], s64 offen offset:0 sc1
    s_nop 1
    v_cvt_pk_bf16_f32 v84, v40, v41
    v_cvt_pk_bf16_f32 v85, v42, v43
    buffer_store_dwordx2 v[84:85], v4, s[48:51], s64 offen offset:1024 sc1
    v_cvt_pk_bf16_f32 v86, v44, v45
    v_cvt_pk_bf16_f32 v87, v46, v47
    buffer_store_dwordx2 v[86:87], v4, s[48:51], s64 offen offset:1536 sc1
    s_add_u32 s64, s64, 4096
    s_branch L_m3
L_m2:
    s_nop 7
    v_cvt_pk_bf16_f32 v72, v48, v49
    v_cvt_pk_bf16_f32 v73, v50, v51
    buffer_store_dwordx2 v[72:73], v4, s[48:51], s64 offen offset:0 sc1
    v_cvt_pk_bf16_f32 v76, v56, v57
    v_cvt_pk_bf16_f32 v77, v58, v59
    buffer_store_dwordx2 v[76:77], v4, s[48:51], s64 offen offset:1024 sc1
    v_cvt_pk_bf16_f32 v78, v60, v61
    v_cvt_pk_bf16_f32 v79, v62, v63
    buffer_store_dwordx2 v[78:79], v4, s[48:51], s64 offen offset:1536 sc1
    s_add_u32 s64, s64, 4096
L_m3:
    v_and_b32 v8, 3, v0
    v_cmp_gt_u32 vcc, s61, v8
    v_add_u32 v8, s60, v8
    v_lshrrev_b32 v9, 3, v8
    v_and_b32 v8, 7, v8
    v_lshlrev_b32 v8, 2, v8
    v_lshl_add_u32 v8, v9, 7, v8
    v_lshrrev_b32 v9, 2, v0
    v_mul_u32_u24 v9, 16384, v9
    v_add_u32 v8, v8, v9
    v_mov_b32 v9, s7
    s_and_b32 s66, vcc_lo, 0xff
    s_mov_b32 s67, 0
    s_mov_b32 s65, 0xf00000
    s_waitcnt vmcnt(0) lgkmcnt(0)
    s_barrier
    s_mov_b64 exec, s[66:67]
    buffer_store_dword v9, v8, s[48:51], s65 offen sc1
    s_mov_b64 exec, -1
    s_endpgm
L_gemm_main:
    s_cmp_lg_u32 s3, 0
    s_cbranch_scc1 L_nt_18
    v_min_u32 v26, 59, v0
    v_mul_u32_u24 v27, 43, v26
    v_lshrrev_b32 v27, 9, v27
    v_mul_u32_u24 v27, 1536, v27
    v_lshl_add_u32 v26, v26, 7, v27
    s_bfe_u32 s64, s2, 0x50003
    s_bfe_u32 s65, s2, 0x20001
    s_lshl_b32 s65, s65, 5
    s_add_u32 s64, s64, s65
    s_mul_i32 s64, s64, 15360
    s_and_b32 s65, s2, 1
    s_mul_i32 s65, s65, 1536
    s_add_u32 s64, s64, s65
    buffer_load_dword v254, v26, s[56:59], s64 offen
L_nt_18:
    s_add_u32 m0, s9, 16384
    s_add_u32 s68, s68, 256
    buffer_load_dwordx4 v80, s[52:55], s68 offen offset:0 lds
    buffer_load_dwordx4 v81, s[52:55], s68 offen offset:1024 lds
    buffer_load_dwordx4 v82, s[52:55], s68 offen offset:2048 lds
    buffer_load_dwordx4 v83, s[52:55], s68 offen offset:3072 lds
    s_setprio 2
    s_mov_b64 s[48:49], s[46:47]
    s_mov_b64 s[60:61], s[42:43]
    s_mov_b32 s62, 0x280000
    s_mov_b32 s63, 0x20000
    s_and_b32 s69, s3, 1
    s_lshr_b32 s70, s3, 1
    s_lshl1_add_u32 s71, s69, s70
    v_lshrrev_b32 v29, 5, v0
    v_lshrrev_b32 v27, 2, v31
    v_lshlrev_b32 v27, 1, v27
    v_and_b32 v26, 1, v31
    v_add_u32 v27, v27, v26
    v_and_b32 v26, 2, v31
    v_lshl_add_u32 v27, v26, 4, v27
    v_lshlrev_b32 v11, 3, v27
    v_and_b32 v26, 1, v30
    v_xor_b32 v25, s70, v26
    v_lshl_add_u32 v27, v25, 3, v27
    s_lshl_b32 s64, s69, 12
    v_xor_b32 v28, v29, v31
    v_lshlrev_b32 v28, 4, v28
    v_lshl_add_u32 v28, v27, 8, v28
    v_add_u32 v84, s64, v28
    v_xor_b32 v85, 32, v84
    v_xor_b32 v86, 64, v84
    v_xor_b32 v87, 96, v84
    v_xor_b32 v88, 128, v84
    v_xor_b32 v89, 160, v84
    v_xor_b32 v90, 192, v84
    v_xor_b32 v91, 224, v84
    s_lshl_b32 s64, s69, 1
    v_add_u32 v27, s64, v25
    v_mul_u32_u24 v27, 49152, v27
    v_lshl_add_u32 v28, v29, 4, v31
    v_lshl_add_u32 v23, v28, 4, v27
    v_bfe_u32 v28, v0, 1, 1
    v_lshl_add_u32 v26, v26, 1, v28
    s_lshl_b32 s64, s70, 2
    v_add_u32 v26, s64, v26
    v_bfe_u32 v28, v0, 3, 1
    v_lshlrev_b32 v28, 2, v28
    v_xor_b32 v26, v26, v28
    v_bfe_u32 v28, v0, 2, 2
    v_lshl_add_u32 v27, v29, 3, v28
    v_lshlrev_b32 v27, 7, v27
    v_lshl_add_u32 v27, v26, 4, v27
    v_and_b32 v26, 1, v0
    v_lshl_add_u32 v21, v26, 3, v27
    v_add_u32 v22, 0x10000, v21
    s_mul_i32 s66, s5, 192
    s_lshl1_add_u32 s67, s6, s66
    s_add_u32 s67, s67, s70
    s_lshl_b32 s67, s67, 10
    s_add_u32 s11, s67, 0x600000
    s_lshl_b32 s66, s66, 10
    s_add_u32 s66, s66, 0x600000
    s_lshr_b32 s67, s6, 2
    s_lshl_b32 s65, s6, 11
    s_add_u32 s13, s66, s65
    s_mul_i32 s66, s5, 768
    s_lshl_b32 s67, s67, 7
    s_add_u32 s66, s66, s67
    s_add_u32 s15, s66, 0xe80000
    s_xor_b32 s100, s15, 128
    s_and_b32 s67, s6, 3
    s_lshl2_add_u32 s14, s67, s15
    s_mov_b32 s43, 0
    s_lshl3_add_u32 s64, s5, s71
    s_mul_i32 s46, s64, 10240
    s_mul_i32 s66, s6, 160
    s_add_u32 s46, s46, s66
    s_lshl_b32 s64, s64, 6
    s_add_u32 s10, s64, 0xe00000
    s_cmp_lt_u32 s3, 2
    s_cselect_b32 s47, 1024, 0
    s_mul_i32 s64, s6, 245760
    s_add_u32 s12, s64, 0xc00000
    s_mul_i32 s64, s6, 1280
    s_add_u32 s4, s64, 0xf00000
    s_lshl_b32 s64, s3, 7
    s_add_u32 s78, s64, s4
    s_add_u32 s79, s78, 32768
    s_mul_i32 s64, s6, 10
    s_add_u32 s64, s64, s3
    s_lshl_b32 s64, s64, 15
    s_lshl_b32 s65, s5, 7
    s_add_u32 s64, s64, s65
    s_add_u32 s42, s64, 0x300000
    s_mul_i32 s64, s6, 5
    s_lshr_b32 s65, s64, 3
    s_add_u32 s64, s64, 4
    s_lshr_b32 s64, s64, 3
    s_sub_u32 s64, s64, s65
    s_lshl_b32 s64, s64, 8
    s_lshl_b32 s65, s65, 8
    s_mul_i32 s66, s3, 48
    s_add_u32 s65, s65, s66
    s_add_u32 s41, s65, 0xe28000
    v_min_u32 v26, 11, v31
    v_and_b32 v27, 1, v30
    v_mul_u32_u24 v27, s64, v27
    v_lshl_add_u32 v8, v26, 2, v27
    v_lshlrev_b32 v26, 4, v0
    v_add_u32 v2, s9, v26
    s_mul_i32 s64, s70, 5120
    v_add_u32 v3, s64, v26
    s_mul_i32 s64, s71, 48
    s_add_u32 s64, s64, s70
    s_lshl_b32 s64, s64, 10
    v_add_u32 v5, s64, v26
    s_xor_b32 s64, s71, 1
    s_mul_i32 s64, s64, 48
    s_add_u32 s64, s64, s70
    s_lshl_b32 s64, s64, 10
    v_add_u32 v6, s64, v26
    v_add_u32 v4, 0x8000, v3
    v_and_b32 v26, 3, v0
    v_lshlrev_b32 v7, 2, v26
    v_lshlrev_b32 v27, 12, v29
    v_bfe_u32 v28, v0, 2, 3
    v_lshl_add_u32 v27, v28, 7, v27
    v_lshl_add_u32 v27, v26, 3, v27
    s_lshl_b32 s64, s71, 5
    v_add_u32 v12, s64, v27
    v_and_b32 v26, 7, v0
    v_lshrrev_b32 v27, 3, v0
    v_min_u32 v28, 2, v27
    v_lshlrev_b32 v28, 2, v28
    v_add_u32 v28, s3, v28
    v_min_u32 v28, 9, v28
    v_lshl_add_u32 v28, v28, 5, v26
    v_lshlrev_b32 v9, 2, v28
    v_lshlrev_b32 v27, 12, v27
    v_lshl_add_u32 v10, v26, 4, v27
    v_mul_u32_u24 v27, 160, v31
    v_lshl_add_u32 v27, v30, 3, v27
    v_add_u32 v13, s9, v27
    v_add_u32 v26, 0, v0
    v_mul_u32_u24 v27, 205, v26
    v_lshrrev_b32 v27, 11, v27
    v_lshrrev_b32 v14, 2, v27
    v_lshlrev_b32 v14, 1, v14
    v_and_b32 v28, 1, v27
    v_add_u32 v14, v14, v28
    v_and_b32 v28, 2, v27
    v_lshl_add_u32 v14, v28, 4, v14
    v_mul_u32_u24 v14, 1280, v14
    v_lshl_add_u32 v14, v26, 4, v14
    v_mul_u32_u24 v28, 160, v27
    v_sub_u32 v14, v14, v28
    v_add_u32 v26, 64, v0
    v_mul_u32_u24 v27, 205, v26
    v_lshrrev_b32 v27, 11, v27
    v_lshrrev_b32 v15, 2, v27
    v_lshlrev_b32 v15, 1, v15
    v_and_b32 v28, 1, v27
    v_add_u32 v15, v15, v28
    v_and_b32 v28, 2, v27
    v_lshl_add_u32 v15, v28, 4, v15
    v_mul_u32_u24 v15, 1280, v15
    v_lshl_add_u32 v15, v26, 4, v15
    v_mul_u32_u24 v28, 160, v27
    v_sub_u32 v15, v15, v28
    v_add_u32 v26, 128, v0
    v_mul_u32_u24 v27, 205, v26
    v_lshrrev_b32 v27, 11, v27
    v_lshrrev_b32 v16, 2, v27
    v_lshlrev_b32 v16, 1, v16
    v_and_b32 v28, 1, v27
    v_add_u32 v16, v16, v28
    v_and_b32 v28, 2, v27
    v_lshl_add_u32 v16, v28, 4, v16
    v_mul_u32_u24 v16, 1280, v16
    v_lshl_add_u32 v16, v26, 4, v16
    v_mul_u32_u24 v28, 160, v27
    v_sub_u32 v16, v16, v28
    v_mul_u32_u24 v25, 65536, v0
    s_load_dword s7, s[44:45], 0
    s_waitcnt vmcnt(4)
    s_barrier
    ds_read_b128 v[96:99], v84 offset:0
    ds_read_b128 v[100:103], v85 offset:0
    s_add_u32 m0, s9, 32768
    s_nop 0
    buffer_load_dwordx4 v17, s[56:59], s73 offen offset:0 lds
    ds_read_b128 v[104:107], v86 offset:0
    ds_read_b128 v[108:111], v87 offset:0
    buffer_load_dwordx4 v18, s[56:59], s73 offen offset:1024 lds
    ds_read_b128 v[112:115], v88 offset:0
    ds_read_b128 v[116:119], v89 offset:0
    buffer_load_dwordx4 v19, s[56:59], s73 offen offset:2048 lds
    ds_read_b128 v[120:123], v90 offset:0
    ds_read_b128 v[124:127], v91 offset:0
    buffer_load_dwordx4 v20, s[56:59], s73 offen offset:3072 lds
    s_add_u32 m0, s9, 49152
    s_add_u32 s68, s68, 256
    buffer_load_dwordx4 v80, s[52:55], s68 offen offset:0 lds
    buffer_load_dwordx4 v81, s[52:55], s68 offen offset:1024 lds
    buffer_load_dwordx4 v82, s[52:55], s68 offen offset:2048 lds
    buffer_load_dwordx4 v83, s[52:55], s68 offen offset:3072 lds
    s_add_u32 m0, s9, 65536
    s_add_u32 s73, s73, 393216
    buffer_load_dwordx4 v17, s[56:59], s73 offen offset:0 lds
    buffer_load_dwordx4 v18, s[56:59], s73 offen offset:1024 lds
    buffer_load_dwordx4 v19, s[56:59], s73 offen offset:2048 lds
    buffer_load_dwordx4 v20, s[56:59], s73 offen offset:3072 lds
    s_waitcnt vmcnt(12)
    s_barrier
    s_waitcnt lgkmcnt(0)
    s_cmp_lg_u32 s7, 0
    s_cbranch_scc0 L_slow_19
L_back_20:
    s_mov_b32 s0, s7
    s_mov_b32 s1, s7
    v_mov_b32 v24, s7
    ds_read_b128 v[128:131], v84 offset:16384
    ds_read_b128 v[132:135], v85 offset:16384
    ds_read_b128 v[136:139], v86 offset:16384
    ds_read_b128 v[140:143], v87 offset:16384
    ds_read_b128 v[144:147], v88 offset:16384
    ds_read_b128 v[148:151], v89 offset:16384
    ds_read_b128 v[152:155], v90 offset:16384
    ds_read_b128 v[156:159], v91 offset:16384
    s_waitcnt vmcnt(8) lgkmcnt(8)
    s_barrier
    ds_read_b64_tr_b16 v[32:33], v21 offset:32768
    ds_read_b64_tr_b16 v[34:35], v21 offset:33280
    s_add_u32 m0, s9, 0
    s_add_u32 s68, s68, 256
    buffer_load_dwordx4 v80, s[52:55], s68 offen offset:0 lds
    ds_read_b64_tr_b16 v[36:37], v21 offset:34816
    ds_read_b64_tr_b16 v[38:39], v21 offset:35328
    buffer_load_dwordx4 v81, s[52:55], s68 offen offset:1024 lds
    ds_read_b64_tr_b16 v[40:41], v21 offset:36864
    ds_read_b64_tr_b16 v[42:43], v21 offset:37376
    buffer_load_dwordx4 v82, s[52:55], s68 offen offset:2048 lds
    ds_read_b64_tr_b16 v[44:45], v21 offset:38912
    ds_read_b64_tr_b16 v[46:47], v21 offset:39424
    buffer_load_dwordx4 v83, s[52:55], s68 offen offset:3072 lds
    s_waitcnt lgkmcnt(4)
    v_mfma_f32_32x32x16_bf16 v[64:79], v[32:35], v[96:99], 0
    ds_read_b64_tr_b16 v[48:49], v21 offset:40960
    ds_read_b64_tr_b16 v[50:51], v21 offset:41472
    ds_read_b64_tr_b16 v[52:53], v21 offset:43008
    ds_read_b64_tr_b16 v[54:55], v21 offset:43520
    v_mfma_f32_32x32x16_bf16 v[64:79], v[36:39], v[100:103], v[64:79]
    ds_read_b64_tr_b16 v[56:57], v21 offset:45056
    ds_read_b64_tr_b16 v[58:59], v21 offset:45568
    ds_read_b64_tr_b16 v[60:61], v21 offset:47104
    ds_read_b64_tr_b16 v[62:63], v21 offset:47616
    s_waitcnt lgkmcnt(8)
    v_mfma_f32_32x32x16_bf16 v[64:79], v[40:43], v[104:107], v[64:79]
    s_waitcnt vmcnt(8)
    s_barrier
    v_mfma_f32_32x32x16_bf16 v[64:79], v[44:47], v[108:111], v[64:79]
    s_add_u32 m0, s9, 16384
    s_add_u32 s73, s73, 393216
    buffer_load_dwordx4 v17, s[56:59], s73 offen offset:0 lds
    s_waitcnt lgkmcnt(4)
    v_mfma_f32_32x32x16_bf16 v[64:79], v[48:51], v[112:115], v[64:79]
    ds_read_b128 v[160:163], v84 offset:49152
    ds_read_b128 v[164:167], v85 offset:49152
    buffer_load_dwordx4 v18, s[56:59], s73 offen offset:1024 lds
    v_mfma_f32_32x32x16_bf16 v[64:79], v[52:55], v[116:119], v[64:79]
    ds_read_b128 v[168:171], v86 offset:49152
    ds_read_b128 v[172:175], v87 offset:49152
    buffer_load_dwordx4 v19, s[56:59], s73 offen offset:2048 lds
    s_waitcnt lgkmcnt(4)
    v_mfma_f32_32x32x16_bf16 v[64:79], v[56:59], v[120:123], v[64:79]
    ds_read_b128 v[176:179], v88 offset:49152
    ds_read_b128 v[180:183], v89 offset:49152
    buffer_load_dwordx4 v20, s[56:59], s73 offen offset:3072 lds
    v_mfma_f32_32x32x16_bf16 v[64:79], v[60:63], v[124:127], v[64:79]
    ds_read_b128 v[184:187], v90 offset:49152
    ds_read_b128 v[188:191], v91 offset:49152
    s_waitcnt vmcnt(8)
    s_barrier
    ds_read_b64_tr_b16 v[32:33], v22 offset:0
    ds_read_b64_tr_b16 v[34:35], v22 offset:512
    s_add_u32 m0, s9, 32768
    s_add_u32 s68, s68, 256
    buffer_load_dwordx4 v80, s[52:55], s68 offen offset:0 lds
    ds_read_b64_tr_b16 v[36:37], v22 offset:2048
    ds_read_b64_tr_b16 v[38:39], v22 offset:2560
    buffer_load_dwordx4 v81, s[52:55], s68 offen offset:1024 lds
    ds_read_b64_tr_b16 v[40:41], v22 offset:4096
    ds_read_b64_tr_b16 v[42:43], v22 offset:4608
    buffer_load_dwordx4 v82, s[52:55], s68 offen offset:2048 lds
    ds_read_b64_tr_b16 v[44:45], v22 offset:6144
    ds_read_b64_tr_b16 v[46:47], v22 offset:6656
    buffer_load_dwordx4 v83, s[52:55], s68 offen offset:3072 lds
    s_waitcnt lgkmcnt(4)
    v_mfma_f32_32x32x16_bf16 v[64:79], v[32:35], v[128:131], v[64:79]
    ds_read_b64_tr_b16 v[48:49], v22 offset:8192
    ds_read_b64_tr_b16 v[50:51], v22 offset:8704
    ds_read_b64_tr_b16 v[52:53], v22 offset:10240
    ds_read_b64_tr_b16 v[54:55], v22 offset:10752
    v_mfma_f32_32x32x16_bf16 v[64:79], v[36:39], v[132:135], v[64:79]
    ds_read_b64_tr_b16 v[56:57], v22 offset:12288
    ds_read_b64_tr_b16 v[58:59], v22 offset:12800
    ds_read_b64_tr_b16 v[60:61], v22 offset:14336
    ds_read_b64_tr_b16 v[62:63], v22 offset:14848
    s_waitcnt lgkmcnt(8)
    v_mfma_f32_32x32x16_bf16 v[64:79], v[40:43], v[136:139], v[64:79]
    s_waitcnt vmcnt(8)
    s_barrier
    v_mfma_f32_32x32x16_bf16 v[64:79], v[44:47], v[140:143], v[64:79]
    s_add_u32 m0, s9, 49152
    s_add_u32 s73, s73, 393216
    buffer_load_dwordx4 v17, s[56:59], s73 offen offset:0 lds
    s_waitcnt lgkmcnt(4)
    v_mfma_f32_32x32x16_bf16 v[64:79], v[48:51], v[144:147], v[64:79]
    ds_read_b128 v[192:195], v84 offset:0
    ds_read_b128 v[196:199], v85 offset:0
    buffer_load_dwordx4 v18, s[56:59], s73 offen offset:1024 lds
    v_mfma_f32_32x32x16_bf16 v[64:79], v[52:55], v[148:151], v[64:79]
    ds_read_b128 v[200:203], v86 offset:0
    ds_read_b128 v[204:207], v87 offset:0
    buffer_load_dwordx4 v19, s[56:59], s73 offen offset:2048 lds
    s_waitcnt lgkmcnt(4)
    v_mfma_f32_32x32x16_bf16 v[64:79], v[56:59], v[152:155], v[64:79]
    ds_read_b128 v[208:211], v88 offset:0
    ds_read_b128 v[212:215], v89 offset:0
    buffer_load_dwordx4 v20, s[56:59], s73 offen offset:3072 lds
    v_mfma_f32_32x32x16_bf16 v[64:79], v[60:63], v[156:159], v[64:79]
    ds_read_b128 v[216:219], v90 offset:0
    ds_read_b128 v[220:223], v91 offset:0
    s_waitcnt vmcnt(8)
    s_barrier
    ds_read_b64_tr_b16 v[32:33], v21 offset:16384
    ds_read_b64_tr_b16 v[34:35], v21 offset:16896
    s_add_u32 m0, s9, 65536
    s_add_u32 s73, s73, 393216
    buffer_load_dwordx4 v17, s[56:59], s73 offen offset:0 lds
    ds_read_b64_tr_b16 v[36:37], v21 offset:18432
    ds_read_b64_tr_b16 v[38:39], v21 offset:18944
    buffer_load_dwordx4 v18, s[56:59], s73 offen offset:1024 lds
    ds_read_b64_tr_b16 v[40:41], v21 offset:20480
    ds_read_b64_tr_b16 v[42:43], v21 offset:20992
    buffer_load_dwordx4 v19, s[56:59], s73 offen offset:2048 lds
    ds_read_b64_tr_b16 v[44:45], v21 offset:22528
    ds_read_b64_tr_b16 v[46:47], v21 offset:23040
    buffer_load_dwordx4 v20, s[56:59], s73 offen offset:3072 lds
    s_waitcnt lgkmcnt(4)
    v_mfma_f32_32x32x16_bf16 v[64:79], v[32:35], v[160:163], v[64:79]
    ds_read_b64_tr_b16 v[48:49], v21 offset:24576
    ds_read_b64_tr_b16 v[50:51], v21 offset:25088
    ds_read_b64_tr_b16 v[52:53], v21 offset:26624
    ds_read_b64_tr_b16 v[54:55], v21 offset:27136
    v_mfma_f32_32x32x16_bf16 v[64:79], v[36:39], v[164:167], v[64:79]
    ds_read_b64_tr_b16 v[56:57], v21 offset:28672
    ds_read_b64_tr_b16 v[58:59], v21 offset:29184
    ds_read_b64_tr_b16 v[60:61], v21 offset:30720
    ds_read_b64_tr_b16 v[62:63], v21 offset:31232
    s_waitcnt lgkmcnt(8)
    v_mfma_f32_32x32x16_bf16 v[64:79], v[40:43], v[168:171], v[64:79]
    s_waitcnt vmcnt(8)
    s_barrier
    v_mfma_f32_32x32x16_bf16 v[64:79], v[44:47], v[172:175], v[64:79]
    s_add_u32 m0, s9, 0
    s_sub_u32 s73, s73, 1572736
    buffer_load_dwordx4 v17, s[56:59], s73 offen offset:0 lds
    s_waitcnt lgkmcnt(4)
    v_mfma_f32_32x32x16_bf16 v[64:79], v[48:51], v[176:179], v[64:79]
    ds_read_b128 v[224:227], v84 offset:32768
    ds_read_b128 v[228:231], v85 offset:32768
    buffer_load_dwordx4 v18, s[56:59], s73 offen offset:1024 lds
    v_mfma_f32_32x32x16_bf16 v[64:79], v[52:55], v[180:183], v[64:79]
    ds_read_b128 v[232:235], v86 offset:32768
    ds_read_b128 v[236:239], v87 offset:32768
    buffer_load_dwordx4 v19, s[56:59], s73 offen offset:2048 lds
    s_waitcnt lgkmcnt(4)
    v_mfma_f32_32x32x16_bf16 v[64:79], v[56:59], v[184:187], v[64:79]
    ds_read_b128 v[240:243], v88 offset:32768
    ds_read_b128 v[244:247], v89 offset:32768
    buffer_load_dwordx4 v20, s[56:59], s73 offen offset:3072 lds
    v_mfma_f32_32x32x16_bf16 v[64:79], v[60:63], v[188:191], v[64:79]
    ds_read_b128 v[248:251], v90 offset:32768
    ds_read_b128 v[252:255], v91 offset:32768
    s_waitcnt vmcnt(8)
    s_barrier
    ds_read_b64_tr_b16 v[32:33], v21 offset:49152
    ds_read_b64_tr_b16 v[34:35], v21 offset:49664
    s_add_u32 m0, s9, 16384
    s_add_u32 s73, s73, 393216
    buffer_load_dwordx4 v17, s[56:59], s73 offen offset:0 lds
    ds_read_b64_tr_b16 v[36:37], v21 offset:51200
    ds_read_b64_tr_b16 v[38:39], v21 offset:51712
    buffer_load_dwordx4 v18, s[56:59], s73 offen offset:1024 lds
    ds_read_b64_tr_b16 v[40:41], v21 offset:53248
    ds_read_b64_tr_b16 v[42:43], v21 offset:53760
    buffer_load_dwordx4 v19, s[56:59], s73 offen offset:2048 lds
    ds_read_b64_tr_b16 v[44:45], v21 offset:55296
    ds_read_b64_tr_b16 v[46:47], v21 offset:55808
    buffer_load_dwordx4 v20, s[56:59], s73 offen offset:3072 lds
    s_waitcnt lgkmcnt(4)
    v_mfma_f32_32x32x16_bf16 v[64:79], v[32:35], v[192:195], v[64:79]
    ds_read_b64_tr_b16 v[48:49], v21 offset:57344
    ds_read_b64_tr_b16 v[50:51], v21 offset:57856
    ds_read_b64_tr_b16 v[52:53], v21 offset:59392
    ds_read_b64_tr_b16 v[54:55], v21 offset:59904
    v_mfma_f32_32x32x16_bf16 v[64:79], v[36:39], v[196:199], v[64:79]
    ds_read_b64_tr_b16 v[56:57], v21 offset:61440
    ds_read_b64_tr_b16 v[58:59], v21 offset:61952
    ds_read_b64_tr_b16 v[60:61], v21 offset:63488
    ds_read_b64_tr_b16 v[62:63], v21 offset:64000
    s_waitcnt lgkmcnt(8)
    v_mfma_f32_32x32x16_bf16 v[64:79], v[40:43], v[200:203], v[64:79]
    s_waitcnt vmcnt(8)
    s_barrier
    v_mfma_f32_32x32x16_bf16 v[64:79], v[44:47], v[204:207], v[64:79]
    s_add_u32 m0, s9, 32768
    s_add_u32 s73, s73, 393216
    buffer_load_dwordx4 v17, s[56:59], s73 offen offset:0 lds
    s_waitcnt lgkmcnt(4)
    v_mfma_f32_32x32x16_bf16 v[64:79], v[48:51], v[208:211], v[64:79]
    ds_read_b64_tr_b16 v[32:33], v22 offset:0
    ds_read_b64_tr_b16 v[34:35], v22 offset:512
    buffer_load_dwordx4 v18, s[56:59], s73 offen offset:1024 lds
    v_mfma_f32_32x32x16_bf16 v[64:79], v[52:55], v[212:215], v[64:79]
    ds_read_b64_tr_b16 v[36:37], v22 offset:2048
    ds_read_b64_tr_b16 v[38:39], v22 offset:2560
    buffer_load_dwordx4 v19, s[56:59], s73 offen offset:2048 lds
    s_waitcnt lgkmcnt(4)
    v_mfma_f32_32x32x16_bf16 v[64:79], v[56:59], v[216:219], v[64:79]
    ds_read_b64_tr_b16 v[40:41], v22 offset:4096
    ds_read_b64_tr_b16 v[42:43], v22 offset:4608
    buffer_load_dwordx4 v20, s[56:59], s73 offen offset:3072 lds
    v_mfma_f32_32x32x16_bf16 v[64:79], v[60:63], v[220:223], v[64:79]
    ds_read_b64_tr_b16 v[44:45], v22 offset:6144
    ds_read_b64_tr_b16 v[46:47], v22 offset:6656
    s_waitcnt lgkmcnt(4)
    v_mfma_f32_32x32x16_bf16 v[64:79], v[32:35], v[224:227], v[64:79]
    ds_read_b64_tr_b16 v[48:49], v22 offset:8192
    ds_read_b64_tr_b16 v[50:51], v22 offset:8704
    ds_read_b64_tr_b16 v[52:53], v22 offset:10240
    ds_read_b64_tr_b16 v[54:55], v22 offset:10752
    v_mfma_f32_32x32x16_bf16 v[64:79], v[36:39], v[228:231], v[64:79]
    ds_read_b64_tr_b16 v[56:57], v22 offset:12288
    ds_read_b64_tr_b16 v[58:59], v22 offset:12800
    ds_read_b64_tr_b16 v[60:61], v22 offset:14336
    ds_read_b64_tr_b16 v[62:63], v22 offset:14848
    s_waitcnt lgkmcnt(8)
    v_mfma_f32_32x32x16_bf16 v[64:79], v[40:43], v[232:235], v[64:79]
    s_waitcnt vmcnt(8)
    s_barrier
    v_mfma_f32_32x32x16_bf16 v[64:79], v[44:47], v[236:239], v[64:79]
    s_add_u32 m0, s9, 49152
    s_add_u32 s73, s73, 393216
    buffer_load_dwordx4 v17, s[56:59], s73 offen offset:0 lds
    s_waitcnt lgkmcnt(4)
    v_mfma_f32_32x32x16_bf16 v[64:79], v[48:51], v[240:243], v[64:79]
    ds_read_b64_tr_b16 v[32:33], v21 offset:0
    ds_read_b64_tr_b16 v[34:35], v21 offset:512
    buffer_load_dwordx4 v18, s[56:59], s73 offen offset:1024 lds
    v_mfma_f32_32x32x16_bf16 v[64:79], v[52:55], v[244:247], v[64:79]
    ds_read_b64_tr_b16 v[36:37], v21 offset:2048
    ds_read_b64_tr_b16 v[38:39], v21 offset:2560
    buffer_load_dwordx4 v19, s[56:59], s73 offen offset:2048 lds
    s_waitcnt lgkmcnt(4)
    v_mfma_f32_32x32x16_bf16 v[64:79], v[56:59], v[248:251], v[64:79]
    ds_read_b64_tr_b16 v[40:41], v21 offset:4096
    ds_read_b64_tr_b16 v[42:43], v21 offset:4608
    buffer_load_dwordx4 v20, s[56:59], s73 offen offset:3072 lds
    v_mfma_f32_32x32x16_bf16 v[64:79], v[60:63], v[252:255], v[64:79]
    ds_read_b64_tr_b16 v[44:45], v21 offset:6144
    ds_read_b64_tr_b16 v[46:47], v21 offset:6656
    s_waitcnt lgkmcnt(4)
    v_mfma_f32_32x32x16_bf16 v[80:95], v[32:35], v[96:99], 0
    ds_read_b64_tr_b16 v[48:49], v21 offset:8192
    ds_read_b64_tr_b16 v[50:51], v21 offset:8704
    ds_read_b64_tr_b16 v[52:53], v21 offset:10240
    ds_read_b64_tr_b16 v[54:55], v21 offset:10752
    v_mfma_f32_32x32x16_bf16 v[80:95], v[36:39], v[100:103], v[80:95]
    ds_read_b64_tr_b16 v[56:57], v21 offset:12288
    ds_read_b64_tr_b16 v[58:59], v21 offset:12800
    ds_read_b64_tr_b16 v[60:61], v21 offset:14336
    ds_read_b64_tr_b16 v[62:63], v21 offset:14848
    v_mul_f32 v28, 0xbfb8aa3b, v64
    v_mul_f32 v29, 0xbfb8aa3b, v65
    v_exp_f32 v28, v28
    v_exp_f32 v29, v29
    v_add_f32 v28, 1.0, v28
    s_waitcnt lgkmcnt(8)
    v_mfma_f32_32x32x16_bf16 v[80:95], v[40:43], v[104:107], v[80:95]
    s_waitcnt vmcnt(8)
    s_barrier
    v_mfma_f32_32x32x16_bf16 v[80:95], v[44:47], v[108:111], v[80:95]
    s_add_u32 m0, s9, 65536
    s_add_u32 s73, s73, 393216
    buffer_load_dwordx4 v17, s[56:59], s73 offen offset:0 lds
    v_add_f32 v29, 1.0, v29
    v_rcp_f32 v28, v28
    v_rcp_f32 v29, v29
    v_mul_f32 v28, v64, v28
    v_mul_f32 v29, v65, v29
    v_cvt_pk_bf16_f32 v64, v28, v29
    s_waitcnt lgkmcnt(4)
    v_mfma_f32_32x32x16_bf16 v[80:95], v[48:51], v[112:115], v[80:95]
    ds_read_b64_tr_b16 v[32:33], v21 offset:16384
    ds_read_b64_tr_b16 v[34:35], v21 offset:16896
    buffer_load_dwordx4 v18, s[56:59], s73 offen offset:1024 lds
    v_mul_f32 v28, 0xbfb8aa3b, v66
    v_mul_f32 v29, 0xbfb8aa3b, v67
    v_exp_f32 v28, v28
    v_exp_f32 v29, v29
    v_add_f32 v28, 1.0, v28
    v_add_f32 v29, 1.0, v29
    v_mfma_f32_32x32x16_bf16 v[80:95], v[52:55], v[116:119], v[80:95]
    ds_read_b64_tr_b16 v[36:37], v21 offset:18432
    ds_read_b64_tr_b16 v[38:39], v21 offset:18944
    buffer_load_dwordx4 v19, s[56:59], s73 offen offset:2048 lds
    v_rcp_f32 v28, v28
    v_rcp_f32 v29, v29
    v_mul_f32 v28, v66, v28
    v_mul_f32 v29, v67, v29
    v_cvt_pk_bf16_f32 v65, v28, v29
    v_mul_f32 v28, 0xbfb8aa3b, v68
    v_mul_f32 v29, 0xbfb8aa3b, v69
    s_waitcnt lgkmcnt(4)
    v_mfma_f32_32x32x16_bf16 v[80:95], v[56:59], v[120:123], v[80:95]
    ds_read_b64_tr_b16 v[40:41], v21 offset:20480
    ds_read_b64_tr_b16 v[42:43], v21 offset:20992
    buffer_load_dwordx4 v20, s[56:59], s73 offen offset:3072 lds
    v_exp_f32 v28, v28
    v_exp_f32 v29, v29
    v_add_f32 v28, 1.0, v28
    v_add_f32 v29, 1.0, v29
    v_rcp_f32 v28, v28
    v_mfma_f32_32x32x16_bf16 v[80:95], v[60:63], v[124:127], v[80:95]
    ds_read_b64_tr_b16 v[44:45], v21 offset:22528
    ds_read_b64_tr_b16 v[46:47], v21 offset:23040
    v_rcp_f32 v29, v29
    v_mul_f32 v28, v68, v28
    v_mul_f32 v29, v69, v29
    v_cvt_pk_bf16_f32 v66, v28, v29
    v_mul_f32 v28, 0xbfb8aa3b, v70
    v_mul_f32 v29, 0xbfb8aa3b, v71
    v_exp_f32 v28, v28
    s_waitcnt lgkmcnt(4)
    v_mfma_f32_32x32x16_bf16 v[80:95], v[32:35], v[128:131], v[80:95]
    ds_read_b64_tr_b16 v[48:49], v21 offset:24576
    ds_read_b64_tr_b16 v[50:51], v21 offset:25088
    ds_read_b64_tr_b16 v[52:53], v21 offset:26624
    ds_read_b64_tr_b16 v[54:55], v21 offset:27136
    v_exp_f32 v29, v29
    v_add_f32 v28, 1.0, v28
    v_add_f32 v29, 1.0, v29
    v_rcp_f32 v28, v28
    v_mfma_f32_32x32x16_bf16 v[80:95], v[36:39], v[132:135], v[80:95]
    ds_read_b64_tr_b16 v[56:57], v21 offset:28672
    ds_read_b64_tr_b16 v[58:59], v21 offset:29184
    ds_read_b64_tr_b16 v[60:61], v21 offset:30720
    ds_read_b64_tr_b16 v[62:63], v21 offset:31232
    v_rcp_f32 v29, v29
    v_mul_f32 v28, v70, v28
    v_mul_f32 v29, v71, v29
    v_cvt_pk_bf16_f32 v67, v28, v29
    v_mul_f32 v28, 0xbfb8aa3b, v72
    v_mul_f32 v29, 0xbfb8aa3b, v73
    s_waitcnt lgkmcnt(8)
    v_mfma_f32_32x32x16_bf16 v[80:95], v[40:43], v[136:139], v[80:95]
    s_waitcnt vmcnt(8)
    s_barrier
    v_mfma_f32_32x32x16_bf16 v[80:95], v[44:47], v[140:143], v[80:95]
    s_add_u32 m0, s9, 0
    s_sub_u32 s73, s73, 1572736
    buffer_load_dwordx4 v17, s[56:59], s73 offen offset:0 lds
    v_exp_f32 v28, v28
    v_exp_f32 v29, v29
    v_add_f32 v28, 1.0, v28
    v_add_f32 v29, 1.0, v29
    v_rcp_f32 v28, v28
    s_waitcnt lgkmcnt(4)
    v_mfma_f32_32x32x16_bf16 v[80:95], v[48:51], v[144:147], v[80:95]
    ds_read_b64_tr_b16 v[32:33], v21 offset:32768
    ds_read_b64_tr_b16 v[34:35], v21 offset:33280
    buffer_load_dwordx4 v18, s[56:59], s73 offen offset:1024 lds
    v_rcp_f32 v29, v29
    v_mul_f32 v28, v72, v28
    v_mul_f32 v29, v73, v29
    v_cvt_pk_bf16_f32 v68, v28, v29
    v_mul_f32 v28, 0xbfb8aa3b, v74
    v_mul_f32 v29, 0xbfb8aa3b, v75
    v_mfma_f32_32x32x16_bf16 v[80:95], v[52:55], v[148:151], v[80:95]
    ds_read_b64_tr_b16 v[36:37], v21 offset:34816
    ds_read_b64_tr_b16 v[38:39], v21 offset:35328
    buffer_load_dwordx4 v19, s[56:59], s73 offen offset:2048 lds
    v_exp_f32 v28, v28
    v_exp_f32 v29, v29
    v_add_f32 v28, 1.0, v28
    v_add_f32 v29, 1.0, v29
    v_rcp_f32 v28, v28
    s_waitcnt lgkmcnt(4)
    v_mfma_f32_32x32x16_bf16 v[80:95], v[56:59], v[152:155], v[80:95]
    ds_read_b64_tr_b16 v[40:41], v21 offset:36864
    ds_read_b64_tr_b16 v[42:43], v21 offset:37376
    buffer_load_dwordx4 v20, s[56:59], s73 offen offset:3072 lds
    v_rcp_f32 v29, v29
    v_mul_f32 v28, v74, v28
    v_mul_f32 v29, v75, v29
    v_cvt_pk_bf16_f32 v69, v28, v29
    v_mul_f32 v28, 0xbfb8aa3b, v76
    v_mul_f32 v29, 0xbfb8aa3b, v77
    v_mfma_f32_32x32x16_bf16 v[80:95], v[60:63], v[156:159], v[80:95]
    ds_read_b64_tr_b16 v[44:45], v21 offset:38912
    ds_read_b64_tr_b16 v[46:47], v21 offset:39424
    v_exp_f32 v28, v28
    v_exp_f32 v29, v29
    v_add_f32 v28, 1.0, v28
    v_add_f32 v29, 1.0, v29
    v_rcp_f32 v28, v28
    v_rcp_f32 v29, v29
    s_waitcnt lgkmcnt(4)
    v_mfma_f32_32x32x16_bf16 v[80:95], v[32:35], v[160:163], v[80:95]
    ds_read_b64_tr_b16 v[48:49], v21 offset:40960
    ds_read_b64_tr_b16 v[50:51], v21 offset:41472
    ds_read_b64_tr_b16 v[52:53], v21 offset:43008
    ds_read_b64_tr_b16 v[54:55], v21 offset:43520
    v_mul_f32 v28, v76, v28
    v_mul_f32 v29, v77, v29
    v_cvt_pk_bf16_f32 v70, v28, v29
    v_mul_f32 v28, 0xbfb8aa3b, v78
    v_mul_f32 v29, 0xbfb8aa3b, v79
    v_exp_f32 v28, v28
    v_mfma_f32_32x32x16_bf16 v[80:95], v[36:39], v[164:167], v[80:95]
    ds_read_b64_tr_b16 v[56:57], v21 offset:45056
    ds_read_b64_tr_b16 v[58:59], v21 offset:45568
    ds_read_b64_tr_b16 v[60:61], v21 offset:47104
    ds_read_b64_tr_b16 v[62:63], v21 offset:47616
    v_exp_f32 v29, v29
    v_add_f32 v28, 1.0, v28
    v_add_f32 v29, 1.0, v29
    v_rcp_f32 v28, v28
    s_waitcnt lgkmcnt(8)
    v_mfma_f32_32x32x16_bf16 v[80:95], v[40:43], v[168:171], v[80:95]
    s_waitcnt vmcnt(8)
    s_barrier
    v_mfma_f32_32x32x16_bf16 v[80:95], v[44:47], v[172:175], v[80:95]
    s_add_u32 m0, s9, 16384
    s_add_u32 s73, s73, 393216
    buffer_load_dwordx4 v17, s[56:59], s73 offen offset:0 lds
    v_rcp_f32 v29, v29
    v_mul_f32 v28, v78, v28
    v_mul_f32 v29, v79, v29
    v_cvt_pk_bf16_f32 v71, v28, v29
    buffer_store_dwordx4 v[64:67], v23, s[48:51], s11 offen offset:0 sc1
    buffer_store_dwordx4 v[68:71], v23, s[48:51], s11 offen offset:512 sc1
    s_waitcnt lgkmcnt(4)
    v_mfma_f32_32x32x16_bf16 v[80:95], v[48:51], v[176:179], v[80:95]
    ds_read_b64_tr_b16 v[32:33], v21 offset:49152
    ds_read_b64_tr_b16 v[34:35], v21 offset:49664
    buffer_load_dwordx4 v18, s[56:59], s73 offen offset:1024 lds
    v_mfma_f32_32x32x16_bf16 v[80:95], v[52:55], v[180:183], v[80:95]
    ds_read_b64_tr_b16 v[36:37], v21 offset:51200
    ds_read_b64_tr_b16 v[38:39], v21 offset:51712
    buffer_load_dwordx4 v19, s[56:59], s73 offen offset:2048 lds
    s_waitcnt lgkmcnt(4)
    v_mfma_f32_32x32x16_bf16 v[80:95], v[56:59], v[184:187], v[80:95]
    ds_read_b64_tr_b16 v[40:41], v21 offset:53248
    ds_read_b64_tr_b16 v[42:43], v21 offset:53760
    buffer_load_dwordx4 v20, s[56:59], s73 offen offset:3072 lds
    v_mfma_f32_32x32x16_bf16 v[80:95], v[60:63], v[188:191], v[80:95]
    ds_read_b64_tr_b16 v[44:45], v21 offset:55296
    ds_read_b64_tr_b16 v[46:47], v21 offset:55808
    s_waitcnt lgkmcnt(4)
    v_mfma_f32_32x32x16_bf16 v[80:95], v[32:35], v[192:195], v[80:95]
    ds_read_b64_tr_b16 v[48:49], v21 offset:57344
    ds_read_b64_tr_b16 v[50:51], v21 offset:57856
    ds_read_b64_tr_b16 v[52:53], v21 offset:59392
    ds_read_b64_tr_b16 v[54:55], v21 offset:59904
    v_mfma_f32_32x32x16_bf16 v[80:95], v[36:39], v[196:199], v[80:95]
    ds_read_b64_tr_b16 v[56:57], v21 offset:61440
    ds_read_b64_tr_b16 v[58:59], v21 offset:61952
    ds_read_b64_tr_b16 v[60:61], v21 offset:63488
    ds_read_b64_tr_b16 v[62:63], v21 offset:64000
    s_waitcnt lgkmcnt(8)
    v_mfma_f32_32x32x16_bf16 v[80:95], v[40:43], v[200:203], v[80:95]
    s_waitcnt vmcnt(10)
    s_barrier
    v_mfma_f32_32x32x16_bf16 v[80:95], v[44:47], v[204:207], v[80:95]
    s_add_u32 m0, s9, 32768
    s_add_u32 s73, s73, 393216
    buffer_load_dwordx4 v17, s[56:59], s73 offen offset:0 lds
    s_waitcnt lgkmcnt(4)
    v_mfma_f32_32x32x16_bf16 v[80:95], v[48:51], v[208:211], v[80:95]
    ds_read_b64_tr_b16 v[32:33], v22 offset:0
    ds_read_b64_tr_b16 v[34:35], v22 offset:512
    buffer_load_dwordx4 v18, s[56:59], s73 offen offset:1024 lds
    v_mfma_f32_32x32x16_bf16 v[80:95], v[52:55], v[212:215], v[80:95]
    ds_read_b64_tr_b16 v[36:37], v22 offset:2048
    ds_read_b64_tr_b16 v[38:39], v22 offset:2560
    buffer_load_dwordx4 v19, s[56:59], s73 offen offset:2048 lds
    s_waitcnt lgkmcnt(4)
    v_mfma_f32_32x32x16_bf16 v[80:95], v[56:59], v[216:219], v[80:95]
    ds_read_b64_tr_b16 v[40:41], v22 offset:4096
    ds_read_b64_tr_b16 v[42:43], v22 offset:4608
    buffer_load_dwordx4 v20, s[56:59], s73 offen offset:3072 lds
    v_mfma_f32_32x32x16_bf16 v[80:95], v[60:63], v[220:223], v[80:95]
    ds_read_b64_tr_b16 v[44:45], v22 offset:6144
    ds_read_b64_tr_b16 v[46:47], v22 offset:6656
    s_waitcnt lgkmcnt(4)
    v_mfma_f32_32x32x16_bf16 v[80:95], v[32:35], v[224:227], v[80:95]
    ds_read_b64_tr_b16 v[48:49], v22 offset:8192
    ds_read_b64_tr_b16 v[50:51], v22 offset:8704
    ds_read_b64_tr_b16 v[52:53], v22 offset:10240
    ds_read_b64_tr_b16 v[54:55], v22 offset:10752
    v_mfma_f32_32x32x16_bf16 v[80:95], v[36:39], v[228:231], v[80:95]
    ds_read_b64_tr_b16 v[56:57], v22 offset:12288
    ds_read_b64_tr_b16 v[58:59], v22 offset:12800
    ds_read_b64_tr_b16 v[60:61], v22 offset:14336
    ds_read_b64_tr_b16 v[62:63], v22 offset:14848
    s_waitcnt lgkmcnt(8)
    v_mfma_f32_32x32x16_bf16 v[80:95], v[40:43], v[232:235], v[80:95]
    s_waitcnt vmcnt(7)
    s_barrier
    s_cmp_lg_u32 s3, 0
    s_cbranch_scc1 L_nf_25
    s_mov_b64 exec, 3
    buffer_store_dword v24, v25, s[48:51], s14 offen offset:0 sc1
    s_mov_b64 exec, -1
L_nf_25:
    v_mfma_f32_32x32x16_bf16 v[80:95], v[44:47], v[236:239], v[80:95]
    buffer_load_dword v1, v8, s[48:51], s41 offen sc1
    s_waitcnt lgkmcnt(4)
    v_mfma_f32_32x32x16_bf16 v[80:95], v[48:51], v[240:243], v[80:95]
    ds_read_b64_tr_b16 v[32:33], v21 offset:0
    ds_read_b64_tr_b16 v[34:35], v21 offset:512
    s_add_u32 m0, s9, 49152
    s_add_u32 s73, s73, 393216
    buffer_load_dwordx4 v17, s[56:59], s73 offen offset:0 lds
    v_mfma_f32_32x32x16_bf16 v[80:95], v[52:55], v[244:247], v[80:95]
    ds_read_b64_tr_b16 v[36:37], v21 offset:2048
    ds_read_b64_tr_b16 v[38:39], v21 offset:2560
    buffer_load_dwordx4 v18, s[56:59], s73 offen offset:1024 lds
    s_waitcnt lgkmcnt(4)
    v_mfma_f32_32x32x16_bf16 v[80:95], v[56:59], v[248:251], v[80:95]
    ds_read_b64_tr_b16 v[40:41], v21 offset:4096
    ds_read_b64_tr_b16 v[42:43], v21 offset:4608
    buffer_load_dwordx4 v19, s[56:59], s73 offen offset:2048 lds
    v_mfma_f32_32x32x16_bf16 v[80:95], v[60:63], v[252:255], v[80:95]
    ds_read_b64_tr_b16 v[44:45], v21 offset:6144
    ds_read_b64_tr_b16 v[46:47], v21 offset:6656
    buffer_load_dwordx4 v20, s[56:59], s73 offen offset:3072 lds
    s_waitcnt lgkmcnt(4)
    v_mfma_f32_32x32x16_bf16 v[64:79], v[32:35], v[96:99], 0
    ds_read_b64_tr_b16 v[48:49], v21 offset:8192
    ds_read_b64_tr_b16 v[50:51], v21 offset:8704
    ds_read_b64_tr_b16 v[52:53], v21 offset:10240
    ds_read_b64_tr_b16 v[54:55], v21 offset:10752
    v_mfma_f32_32x32x16_bf16 v[64:79], v[36:39], v[100:103], v[64:79]
    ds_read_b64_tr_b16 v[56:57], v21 offset:12288
    ds_read_b64_tr_b16 v[58:59], v21 offset:12800
    ds_read_b64_tr_b16 v[60:61], v21 offset:14336
    ds_read_b64_tr_b16 v[62:63], v21 offset:14848
    v_mul_f32 v28, 0xbfb8aa3b, v80
    v_mul_f32 v29, 0xbfb8aa3b, v81
    v_exp_f32 v28, v28
    v_exp_f32 v29, v29
    v_add_f32 v28, 1.0, v28
    s_waitcnt lgkmcnt(8)
    v_mfma_f32_32x32x16_bf16 v[64:79], v[40:43], v[104:107], v[64:79]
    s_waitcnt vmcnt(9)
    s_barrier
    v_mfma_f32_32x32x16_bf16 v[64:79], v[44:47], v[108:111], v[64:79]
    s_add_u32 m0, s9, 65536
    s_add_u32 s73, s73, 393216
    buffer_load_dwordx4 v17, s[56:59], s73 offen offset:0 lds
    v_add_f32 v29, 1.0, v29
    v_rcp_f32 v28, v28
    v_rcp_f32 v29, v29
    v_mul_f32 v28, v80, v28
    v_mul_f32 v29, v81, v29
    v_cvt_pk_bf16_f32 v80, v28, v29
    s_waitcnt lgkmcnt(4)
    v_mfma_f32_32x32x16_bf16 v[64:79], v[48:51], v[112:115], v[64:79]
    ds_read_b64_tr_b16 v[32:33], v21 offset:16384
    ds_read_b64_tr_b16 v[34:35], v21 offset:16896
    buffer_load_dwordx4 v18, s[56:59], s73 offen offset:1024 lds
    v_mul_f32 v28, 0xbfb8aa3b, v82
    v_mul_f32 v29, 0xbfb8aa3b, v83
    v_exp_f32 v28, v28
    v_exp_f32 v29, v29
    v_add_f32 v28, 1.0, v28
    v_add_f32 v29, 1.0, v29
    v_mfma_f32_32x32x16_bf16 v[64:79], v[52:55], v[116:119], v[64:79]
    ds_read_b64_tr_b16 v[36:37], v21 offset:18432
    ds_read_b64_tr_b16 v[38:39], v21 offset:18944
    buffer_load_dwordx4 v19, s[56:59], s73 offen offset:2048 lds
    v_rcp_f32 v28, v28
    v_rcp_f32 v29, v29
    v_mul_f32 v28, v82, v28
    v_mul_f32 v29, v83, v29
    v_cvt_pk_bf16_f32 v81, v28, v29
    v_mul_f32 v28, 0xbfb8aa3b, v84
    v_mul_f32 v29, 0xbfb8aa3b, v85
    s_waitcnt lgkmcnt(4)
    v_mfma_f32_32x32x16_bf16 v[64:79], v[56:59], v[120:123], v[64:79]
    ds_read_b64_tr_b16 v[40:41], v21 offset:20480
    ds_read_b64_tr_b16 v[42:43], v21 offset:20992
    buffer_load_dwordx4 v20, s[56:59], s73 offen offset:3072 lds
    v_exp_f32 v28, v28
    v_exp_f32 v29, v29
    v_add_f32 v28, 1.0, v28
    v_add_f32 v29, 1.0, v29
    v_rcp_f32 v28, v28
    v_mfma_f32_32x32x16_bf16 v[64:79], v[60:63], v[124:127], v[64:79]
    ds_read_b64_tr_b16 v[44:45], v21 offset:22528
    ds_read_b64_tr_b16 v[46:47], v21 offset:23040
    v_rcp_f32 v29, v29
    v_mul_f32 v28, v84, v28
    v_mul_f32 v29, v85, v29
    v_cvt_pk_bf16_f32 v82, v28, v29
    v_mul_f32 v28, 0xbfb8aa3b, v86
    v_mul_f32 v29, 0xbfb8aa3b, v87
    v_exp_f32 v28, v28
    s_waitcnt lgkmcnt(4)
    v_mfma_f32_32x32x16_bf16 v[64:79], v[32:35], v[128:131], v[64:79]
    ds_read_b64_tr_b16 v[48:49], v21 offset:24576
    ds_read_b64_tr_b16 v[50:51], v21 offset:25088
    ds_read_b64_tr_b16 v[52:53], v21 offset:26624
    ds_read_b64_tr_b16 v[54:55], v21 offset:27136
    v_exp_f32 v29, v29
    v_add_f32 v28, 1.0, v28
    v_add_f32 v29, 1.0, v29
    v_rcp_f32 v28, v28
    v_mfma_f32_32x32x16_bf16 v[64:79], v[36:39], v[132:135], v[64:79]
    ds_read_b64_tr_b16 v[56:57], v21 offset:28672
    ds_read_b64_tr_b16 v[58:59], v21 offset:29184
    ds_read_b64_tr_b16 v[60:61], v21 offset:30720
    ds_read_b64_tr_b16 v[62:63], v21 offset:31232
    v_rcp_f32 v29, v29
    v_mul_f32 v28, v86, v28
    v_mul_f32 v29, v87, v29
    v_cvt_pk_bf16_f32 v83, v28, v29
    v_mul_f32 v28, 0xbfb8aa3b, v88
    v_mul_f32 v29, 0xbfb8aa3b, v89
    s_waitcnt lgkmcnt(8)
    v_mfma_f32_32x32x16_bf16 v[64:79], v[40:43], v[136:139], v[64:79]
    s_waitcnt vmcnt(8)
    v_cmp_ne_u32 vcc, s7, v1
    s_nop 0
    s_cmp_eq_u64 vcc, 0
    s_cbranch_scc0 L_slow_26
L_back_27:
    s_waitcnt vmcnt(9)
    s_barrier
    v_mfma_f32_32x32x16_bf16 v[64:79], v[44:47], v[140:143], v[64:79]
    s_add_u32 m0, s9, 0
    s_nop 0
    buffer_load_dwordx4 v2, s[48:51], s12 offen offset:0 sc1 lds
    v_exp_f32 v28, v28
    v_exp_f32 v29, v29
    v_add_f32 v28, 1.0, v28
    v_add_f32 v29, 1.0, v29
    v_rcp_f32 v28, v28
    s_waitcnt lgkmcnt(4)
    v_mfma_f32_32x32x16_bf16 v[64:79], v[48:51], v[144:147], v[64:79]
    ds_read_b64_tr_b16 v[32:33], v21 offset:32768
    ds_read_b64_tr_b16 v[34:35], v21 offset:33280
    buffer_load_dwordx4 v2, s[48:51], s12 offen offset:1024 sc1 lds
    v_rcp_f32 v29, v29
    v_mul_f32 v28, v88, v28
    v_mul_f32 v29, v89, v29
    v_cvt_pk_bf16_f32 v84, v28, v29
    v_mul_f32 v28, 0xbfb8aa3b, v90
    v_mul_f32 v29, 0xbfb8aa3b, v91
    v_mfma_f32_32x32x16_bf16 v[64:79], v[52:55], v[148:151], v[64:79]
    ds_read_b64_tr_b16 v[36:37], v21 offset:34816
    ds_read_b64_tr_b16 v[38:39], v21 offset:35328
    buffer_load_dwordx4 v2, s[48:51], s12 offen offset:2048 sc1 lds
    v_exp_f32 v28, v28
    v_exp_f32 v29, v29
    v_add_f32 v28, 1.0, v28
    v_add_f32 v29, 1.0, v29
    v_rcp_f32 v28, v28
    s_waitcnt lgkmcnt(4)
    v_mfma_f32_32x32x16_bf16 v[64:79], v[56:59], v[152:155], v[64:79]
    ds_read_b64_tr_b16 v[40:41], v21 offset:36864
    ds_read_b64_tr_b16 v[42:43], v21 offset:37376
    buffer_load_dwordx4 v2, s[48:51], s12 offen offset:3072 sc1 lds
    v_rcp_f32 v29, v29
    v_mul_f32 v28, v90, v28
    v_mul_f32 v29, v91, v29
    v_cvt_pk_bf16_f32 v85, v28, v29
    v_mul_f32 v28, 0xbfb8aa3b, v92
    v_mul_f32 v29, 0xbfb8aa3b, v93
    v_mfma_f32_32x32x16_bf16 v[64:79], v[60:63], v[156:159], v[64:79]
    ds_read_b64_tr_b16 v[44:45], v21 offset:38912
    ds_read_b64_tr_b16 v[46:47], v21 offset:39424
    v_exp_f32 v28, v28
    v_exp_f32 v29, v29
    v_add_f32 v28, 1.0, v28
    v_add_f32 v29, 1.0, v29
    v_rcp_f32 v28, v28
    v_rcp_f32 v29, v29
    s_waitcnt lgkmcnt(4)
    v_mfma_f32_32x32x16_bf16 v[64:79], v[32:35], v[160:163], v[64:79]
    ds_read_b64_tr_b16 v[48:49], v21 offset:40960
    ds_read_b64_tr_b16 v[50:51], v21 offset:41472
    ds_read_b64_tr_b16 v[52:53], v21 offset:43008
    ds_read_b64_tr_b16 v[54:55], v21 offset:43520
    v_mul_f32 v28, v92, v28
    v_mul_f32 v29, v93, v29
    v_cvt_pk_bf16_f32 v86, v28, v29
    v_mul_f32 v28, 0xbfb8aa3b, v94
    v_mul_f32 v29, 0xbfb8aa3b, v95
    v_exp_f32 v28, v28
    v_mfma_f32_32x32x16_bf16 v[64:79], v[36:39], v[164:167], v[64:79]
    ds_read_b64_tr_b16 v[56:57], v21 offset:45056
    ds_read_b64_tr_b16 v[58:59], v21 offset:45568
    ds_read_b64_tr_b16 v[60:61], v21 offset:47104
    ds_read_b64_tr_b16 v[62:63], v21 offset:47616
    v_exp_f32 v29, v29
    v_add_f32 v28, 1.0, v28
    v_add_f32 v29, 1.0, v29
    v_rcp_f32 v28, v28
    s_waitcnt lgkmcnt(8)
    v_mfma_f32_32x32x16_bf16 v[64:79], v[40:43], v[168:171], v[64:79]
    s_waitcnt vmcnt(8)
    s_barrier
    s_load_dwordx4 s[16:19], s[48:49], s15 offset:0
    v_mfma_f32_32x32x16_bf16 v[64:79], v[44:47], v[172:175], v[64:79]
    s_add_u32 m0, s9, 16384
    s_add_u32 s12, s12, 16384
    buffer_load_dwordx4 v2, s[48:51], s12 offen offset:0 sc1 lds
    v_rcp_f32 v29, v29
    v_mul_f32 v28, v94, v28
    v_mul_f32 v29, v95, v29
    v_cvt_pk_bf16_f32 v87, v28, v29
    s_add_u32 s11, s11, 16384
    buffer_store_dwordx4 v[80:83], v23, s[48:51], s11 offen offset:0 sc1
    buffer_store_dwordx4 v[84:87], v23, s[48:51], s11 offen offset:512 sc1
    s_waitcnt lgkmcnt(4)
    v_mfma_f32_32x32x16_bf16 v[64:79], v[48:51], v[176:179], v[64:79]
    ds_read_b64_tr_b16 v[32:33], v21 offset:49152
    ds_read_b64_tr_b16 v[34:35], v21 offset:49664
    buffer_load_dwordx4 v2, s[48:51], s12 offen offset:1024 sc1 lds
    v_permlane32_swap_b32 v80, v84
    v_permlane32_swap_b32 v81, v85
    v_permlane32_swap_b32 v82, v86
    v_permlane32_swap_b32 v83, v87
    v_permlane16_swap_b32 v80, v84
    v_permlane16_swap_b32 v81, v85
    v_permlane16_swap_b32 v82, v86
    v_permlane16_swap_b32 v83, v87
    v_mfma_f32_32x32x16_bf16 v[64:79], v[52:55], v[180:183], v[64:79]
    ds_read_b64_tr_b16 v[36:37], v21 offset:51200
    ds_read_b64_tr_b16 v[38:39], v21 offset:51712
    buffer_load_dwordx4 v2, s[48:51], s12 offen offset:2048 sc1 lds
    s_waitcnt lgkmcnt(4)
    v_mfma_f32_32x32x16_bf16 v[64:79], v[56:59], v[184:187], v[64:79]
    ds_read_b64_tr_b16 v[40:41], v21 offset:53248
    ds_read_b64_tr_b16 v[42:43], v21 offset:53760
    buffer_load_dwordx4 v2, s[48:51], s12 offen offset:3072 sc1 lds
    v_mfma_f32_32x32x16_bf16 v[64:79], v[60:63], v[188:191], v[64:79]
    ds_read_b64_tr_b16 v[44:45], v21 offset:55296
    ds_read_b64_tr_b16 v[46:47], v21 offset:55808
    s_waitcnt lgkmcnt(4)
    v_mfma_f32_32x32x16_bf16 v[64:79], v[32:35], v[192:195], v[64:79]
    ds_read_b64_tr_b16 v[48:49], v21 offset:57344
    ds_read_b64_tr_b16 v[50:51], v21 offset:57856
    ds_read_b64_tr_b16 v[52:53], v21 offset:59392
    ds_read_b64_tr_b16 v[54:55], v21 offset:59904
    v_mfma_f32_32x32x16_bf16 v[64:79], v[36:39], v[196:199], v[64:79]
    ds_read_b64_tr_b16 v[56:57], v21 offset:61440
    ds_read_b64_tr_b16 v[58:59], v21 offset:61952
    ds_read_b64_tr_b16 v[60:61], v21 offset:63488
    ds_read_b64_tr_b16 v[62:63], v21 offset:64000
    s_waitcnt lgkmcnt(8)
    v_mfma_f32_32x32x16_bf16 v[64:79], v[40:43], v[200:203], v[64:79]
    s_waitcnt vmcnt(10) lgkmcnt(0)
    s_barrier
    s_xor_b64 s[16:17], s[16:17], s[0:1]
    s_xor_b64 s[18:19], s[18:19], s[0:1]
    s_or_b64 s[16:17], s[16:17], s[18:19]
    s_cbranch_scc1 L_slow_30
L_back_31:
    v_mfma_f32_32x32x16_bf16 v[64:79], v[44:47], v[204:207], v[64:79]
    s_add_u32 m0, s9, 32768
    s_add_u32 s12, s12, 16384
    buffer_load_dwordx4 v2, s[48:51], s12 offen offset:0 sc1 lds
    s_waitcnt lgkmcnt(4)
    v_mfma_f32_32x32x16_bf16 v[64:79], v[48:51], v[208:211], v[64:79]
    ds_read_b64_tr_b16 v[32:33], v22 offset:0
    ds_read_b64_tr_b16 v[34:35], v22 offset:512
    buffer_load_dwordx4 v2, s[48:51], s12 offen offset:1024 sc1 lds
    v_mfma_f32_32x32x16_bf16 v[64:79], v[52:55], v[212:215], v[64:79]
    ds_read_b64_tr_b16 v[36:37], v22 offset:2048
    ds_read_b64_tr_b16 v[38:39], v22 offset:2560
    buffer_load_dwordx4 v2, s[48:51], s12 offen offset:2048 sc1 lds
    s_waitcnt lgkmcnt(4)
    v_mfma_f32_32x32x16_bf16 v[64:79], v[56:59], v[216:219], v[64:79]
    ds_read_b64_tr_b16 v[40:41], v22 offset:4096
    ds_read_b64_tr_b16 v[42:43], v22 offset:4608
    buffer_load_dwordx4 v2, s[48:51], s12 offen offset:3072 sc1 lds
    v_mfma_f32_32x32x16_bf16 v[64:79], v[60:63], v[220:223], v[64:79]
    ds_read_b64_tr_b16 v[44:45], v22 offset:6144
    ds_read_b64_tr_b16 v[46:47], v22 offset:6656
    buffer_load_dwordx4 v[136:139], v5, s[48:51], s13 offen sc1
    s_waitcnt lgkmcnt(4)
    v_mfma_f32_32x32x16_bf16 v[64:79], v[32:35], v[224:227], v[64:79]
    ds_read_b64_tr_b16 v[48:49], v22 offset:8192
    ds_read_b64_tr_b16 v[50:51], v22 offset:8704
    ds_read_b64_tr_b16 v[52:53], v22 offset:10240
    ds_read_b64_tr_b16 v[54:55], v22 offset:10752
    buffer_load_dwordx4 v[140:143], v6, s[48:51], s13 offen sc1
    v_mfma_f32_32x32x16_bf16 v[64:79], v[36:39], v[228:231], v[64:79]
    ds_read_b64_tr_b16 v[56:57], v22 offset:12288
    ds_read_b64_tr_b16 v[58:59], v22 offset:12800
    ds_read_b64_tr_b16 v[60:61], v22 offset:14336
    ds_read_b64_tr_b16 v[62:63], v22 offset:14848
    s_xor_b32 s65, s13, 2048
    buffer_load_dwordx4 v[144:147], v5, s[48:51], s65 offen sc1
    s_waitcnt lgkmcnt(8)
    v_mfma_f32_32x32x16_bf16 v[64:79], v[40:43], v[232:235], v[64:79]
    s_waitcnt vmcnt(10)
    s_barrier
    s_cmp_lg_u32 s3, 1
    s_cbranch_scc1 L_nf_37
    s_mov_b64 exec, 3
    buffer_store_dword v24, v25, s[48:51], s14 offen offset:256 sc1
    s_mov_b64 exec, -1
L_nf_37:
    s_load_dwordx4 s[16:19], s[48:49], s100 offset:0
    v_mfma_f32_32x32x16_bf16 v[64:79], v[44:47], v[236:239], v[64:79]
    buffer_load_dwordx4 v[148:151], v6, s[48:51], s65 offen sc1
    s_waitcnt lgkmcnt(4)
    v_mfma_f32_32x32x16_bf16 v[64:79], v[48:51], v[240:243], v[64:79]
    ds_read_b128 v[32:35], v3 offset:0
    s_xor_b32 s65, s13, 4096
    buffer_load_dwordx4 v[152:155], v5, s[48:51], s65 offen sc1
    buffer_load_dwordx4 v[156:159], v6, s[48:51], s65 offen sc1
    v_mfma_f32_32x32x16_bf16 v[64:79], v[52:55], v[244:247], v[64:79]
    ds_read_b128 v[36:39], v3 offset:1024
    s_xor_b32 s65, s13, 6144
    buffer_load_dwordx4 v[160:163], v5, s[48:51], s65 offen sc1
    buffer_load_dwordx4 v[164:167], v6, s[48:51], s65 offen sc1
    s_waitcnt lgkmcnt(2)
    v_mfma_f32_32x32x16_bf16 v[64:79], v[56:59], v[248:251], v[64:79]
    ds_read_b128 v[40:43], v3 offset:2048
    s_add_u32 m0, s9, 49152
    s_add_u32 s12, s12, 16384
    buffer_load_dwordx4 v2, s[48:51], s12 offen offset:0 sc1 lds
    buffer_load_dwordx4 v2, s[48:51], s12 offen offset:1024 sc1 lds
    v_mfma_f32_32x32x16_bf16 v[64:79], v[60:63], v[252:255], v[64:79]
    ds_read_b128 v[44:47], v3 offset:3072
    ds_read_b128 v[48:51], v3 offset:4096
    buffer_load_dwordx4 v2, s[48:51], s12 offen offset:2048 sc1 lds
    buffer_load_dwordx4 v2, s[48:51], s12 offen offset:3072 sc1 lds
    s_waitcnt vmcnt(10) lgkmcnt(3)
    v_mfma_f32_16x16x32_bf16 v[116:119], v[32:35], v[140:143], 0
    ds_read_b128 v[52:55], v3 offset:10240
    v_mfma_f32_16x16x32_bf16 v[96:99], v[32:35], v[136:139], 0
    s_waitcnt vmcnt(16) lgkmcnt(0)
    s_barrier
    s_xor_b64 s[16:17], s[16:17], s[0:1]
    s_xor_b64 s[18:19], s[18:19], s[0:1]
    s_or_b64 s[16:17], s[16:17], s[18:19]
    s_cbranch_scc1 L_slow_38
L_back_39:
    v_mfma_f32_16x16x32_bf16 v[120:123], v[36:39], v[140:143], 0
    ds_read_b128 v[56:59], v3 offset:11264
    v_mfma_f32_16x16x32_bf16 v[100:103], v[36:39], v[136:139], 0
    s_add_u32 m0, s9, 65536
    s_add_u32 s12, s12, 16384
    buffer_load_dwordx4 v2, s[48:51], s12 offen offset:0 sc1 lds
    s_waitcnt lgkmcnt(3)
    v_mfma_f32_16x16x32_bf16 v[124:127], v[40:43], v[140:143], 0
    ds_read_b128 v[60:63], v3 offset:12288
    v_mfma_f32_16x16x32_bf16 v[104:107], v[40:43], v[136:139], 0
    buffer_load_dwordx4 v2, s[48:51], s12 offen offset:1024 sc1 lds
    v_mul_f32 v28, 0xbfb8aa3b, v64
    v_mul_f32 v29, 0xbfb8aa3b, v65
    v_exp_f32 v28, v28
    v_exp_f32 v29, v29
    v_add_f32 v28, 1.0, v28
    v_add_f32 v29, 1.0, v29
    v_mfma_f32_16x16x32_bf16 v[128:131], v[44:47], v[140:143], 0
    ds_read_b128 v[32:35], v3 offset:13312
    v_mfma_f32_16x16x32_bf16 v[108:111], v[44:47], v[136:139], 0
    buffer_load_dwordx4 v2, s[48:51], s12 offen offset:2048 sc1 lds
    v_rcp_f32 v28, v28
    v_rcp_f32 v29, v29
    v_mul_f32 v28, v64, v28
    v_mul_f32 v29, v65, v29
    v_cvt_pk_bf16_f32 v64, v28, v29
    v_mul_f32 v28, 0xbfb8aa3b, v66
    s_waitcnt lgkmcnt(3)
    v_mfma_f32_16x16x32_bf16 v[132:135], v[48:51], v[140:143], 0
    ds_read_b128 v[36:39], v3 offset:14336
    v_mfma_f32_16x16x32_bf16 v[112:115], v[48:51], v[136:139], 0
    buffer_load_dwordx4 v2, s[48:51], s12 offen offset:3072 sc1 lds
    v_mul_f32 v29, 0xbfb8aa3b, v67
    v_exp_f32 v28, v28
    v_exp_f32 v29, v29
    v_add_f32 v28, 1.0, v28
    v_add_f32 v29, 1.0, v29
    v_rcp_f32 v28, v28
    s_waitcnt vmcnt(12)
    v_mfma_f32_16x16x32_bf16 v[116:119], v[52:55], v[148:151], v[116:119]
    ds_read_b128 v[40:43], v3 offset:20480
    v_mfma_f32_16x16x32_bf16 v[96:99], v[52:55], v[144:147], v[96:99]
    s_xor_b32 s65, s13, 8192
    buffer_load_dwordx4 v[168:171], v5, s[48:51], s65 offen sc1
    v_rcp_f32 v29, v29
    v_mul_f32 v28, v66, v28
    v_mul_f32 v29, v67, v29
    v_cvt_pk_bf16_f32 v65, v28, v29
    v_mul_f32 v28, 0xbfb8aa3b, v68
    v_mul_f32 v29, 0xbfb8aa3b, v69
    s_waitcnt lgkmcnt(3)
    v_mfma_f32_16x16x32_bf16 v[120:123], v[56:59], v[148:151], v[120:123]
    ds_read_b128 v[44:47], v3 offset:21504
    v_mfma_f32_16x16x32_bf16 v[100:103], v[56:59], v[144:147], v[100:103]
    buffer_load_dwordx4 v[172:175], v6, s[48:51], s65 offen sc1
    v_exp_f32 v28, v28
    v_exp_f32 v29, v29
    v_add_f32 v28, 1.0, v28
    v_add_f32 v29, 1.0, v29
    v_rcp_f32 v28, v28
    v_rcp_f32 v29, v29
    v_mfma_f32_16x16x32_bf16 v[124:127], v[60:63], v[148:151], v[124:127]
    ds_read_b128 v[48:51], v3 offset:22528
    v_mfma_f32_16x16x32_bf16 v[104:107], v[60:63], v[144:147], v[104:107]
    s_xor_b32 s65, s13, 10240
    buffer_load_dwordx4 v[176:179], v5, s[48:51], s65 offen sc1
    v_mul_f32 v28, v68, v28
    v_mul_f32 v29, v69, v29
    v_cvt_pk_bf16_f32 v66, v28, v29
    v_mul_f32 v28, 0xbfb8aa3b, v70
    v_mul_f32 v29, 0xbfb8aa3b, v71
    v_exp_f32 v28, v28
    s_waitcnt lgkmcnt(3)
    v_mfma_f32_16x16x32_bf16 v[128:131], v[32:35], v[148:151], v[128:131]
    ds_read_b128 v[52:55], v3 offset:23552
    v_mfma_f32_16x16x32_bf16 v[108:111], v[32:35], v[144:147], v[108:111]
    buffer_load_dwordx4 v[180:183], v6, s[48:51], s65 offen sc1
    v_exp_f32 v29, v29
    v_add_f32 v28, 1.0, v28
    v_add_f32 v29, 1.0, v29
    v_rcp_f32 v28, v28
    v_rcp_f32 v29, v29
    v_mul_f32 v28, v70, v28
    v_mfma_f32_16x16x32_bf16 v[132:135], v[36:39], v[148:151], v[132:135]
    ds_read_b128 v[56:59], v3 offset:24576
    v_mfma_f32_16x16x32_bf16 v[112:115], v[36:39], v[144:147], v[112:115]
    s_xor_b32 s65, s13, 12288
    buffer_load_dwordx4 v[184:187], v5, s[48:51], s65 offen sc1
    v_mul_f32 v29, v71, v29
    v_cvt_pk_bf16_f32 v67, v28, v29
    v_mul_f32 v28, 0xbfb8aa3b, v72
    v_mul_f32 v29, 0xbfb8aa3b, v73
    v_exp_f32 v28, v28
    v_exp_f32 v29, v29
    s_waitcnt vmcnt(21)
    s_barrier
    s_load_dwordx4 s[16:19], s[48:49], s15 offset:256
    s_waitcnt vmcnt(15) lgkmcnt(3)
    v_mfma_f32_16x16x32_bf16 v[116:119], v[40:43], v[156:159], v[116:119]
    ds_read_b128 v[60:63], v3 offset:30720
    v_mfma_f32_16x16x32_bf16 v[96:99], v[40:43], v[152:155], v[96:99]
    buffer_load_dwordx4 v[188:191], v6, s[48:51], s65 offen sc1
    v_add_f32 v28, 1.0, v28
    v_add_f32 v29, 1.0, v29
    v_rcp_f32 v28, v28
    v_rcp_f32 v29, v29
    v_mul_f32 v28, v72, v28
    v_mul_f32 v29, v73, v29
    v_mfma_f32_16x16x32_bf16 v[120:123], v[44:47], v[156:159], v[120:123]
    ds_read_b128 v[32:35], v3 offset:31744
    v_mfma_f32_16x16x32_bf16 v[100:103], v[44:47], v[152:155], v[100:103]
    s_add_u32 m0, s9, 0
    s_add_u32 s12, s12, 16384
    buffer_load_dwordx4 v2, s[48:51], s12 offen offset:0 sc1 lds
    v_cvt_pk_bf16_f32 v68, v28, v29
    v_mul_f32 v28, 0xbfb8aa3b, v74
    v_mul_f32 v29, 0xbfb8aa3b, v75
    v_exp_f32 v28, v28
    v_exp_f32 v29, v29
    v_add_f32 v28, 1.0, v28
    s_waitcnt lgkmcnt(3)
    v_mfma_f32_16x16x32_bf16 v[124:127], v[48:51], v[156:159], v[124:127]
    ds_read_b128 v[36:39], v4 offset:0
    v_mfma_f32_16x16x32_bf16 v[104:107], v[48:51], v[152:155], v[104:107]
    buffer_load_dwordx4 v2, s[48:51], s12 offen offset:1024 sc1 lds
    v_add_f32 v29, 1.0, v29
    v_rcp_f32 v28, v28
    v_rcp_f32 v29, v29
    v_mul_f32 v28, v74, v28
    v_mul_f32 v29, v75, v29
    v_cvt_pk_bf16_f32 v69, v28, v29
    v_mfma_f32_16x16x32_bf16 v[128:131], v[52:55], v[156:159], v[128:131]
    ds_read_b128 v[40:43], v4 offset:1024
    v_mfma_f32_16x16x32_bf16 v[108:111], v[52:55], v[152:155], v[108:111]
    buffer_load_dwordx4 v2, s[48:51], s12 offen offset:2048 sc1 lds
    v_mul_f32 v28, 0xbfb8aa3b, v76
    v_mul_f32 v29, 0xbfb8aa3b, v77
    v_exp_f32 v28, v28
    v_exp_f32 v29, v29
    v_add_f32 v28, 1.0, v28
    v_add_f32 v29, 1.0, v29
    s_waitcnt lgkmcnt(3)
    v_mfma_f32_16x16x32_bf16 v[132:135], v[56:59], v[156:159], v[132:135]
    ds_read_b128 v[44:47], v4 offset:2048
    v_mfma_f32_16x16x32_bf16 v[112:115], v[56:59], v[152:155], v[112:115]
    buffer_load_dwordx4 v2, s[48:51], s12 offen offset:3072 sc1 lds
    v_rcp_f32 v28, v28
    v_rcp_f32 v29, v29
    v_mul_f32 v28, v76, v28
    v_mul_f32 v29, v77, v29
    v_cvt_pk_bf16_f32 v70, v28, v29
    v_mul_f32 v28, 0xbfb8aa3b, v78
    s_waitcnt vmcnt(18)
    v_mfma_f32_16x16x32_bf16 v[116:119], v[60:63], v[164:167], v[116:119]
    ds_read_b128 v[48:51], v4 offset:8192
    v_mfma_f32_16x16x32_bf16 v[96:99], v[60:63], v[160:163], v[96:99]
    s_xor_b32 s65, s13, 14336
    buffer_load_dwordx4 v[192:195], v5, s[48:51], s65 offen sc1
    v_mul_f32 v29, 0xbfb8aa3b, v79
    v_exp_f32 v28, v28
    v_exp_f32 v29, v29
    v_add_f32 v28, 1.0, v28
    v_add_f32 v29, 1.0, v29
    v_rcp_f32 v28, v28
    s_waitcnt lgkmcnt(3)
    v_mfma_f32_16x16x32_bf16 v[120:123], v[32:35], v[164:167], v[120:123]
    ds_read_b128 v[52:55], v4 offset:9216
    v_mfma_f32_16x16x32_bf16 v[100:103], v[32:35], v[160:163], v[100:103]
    buffer_load_dwordx4 v[196:199], v6, s[48:51], s65 offen sc1
    v_rcp_f32 v29, v29
    v_mul_f32 v28, v78, v28
    v_mul_f32 v29, v79, v29
    v_cvt_pk_bf16_f32 v71, v28, v29
    s_add_u32 s11, s11, 16384
    buffer_store_dwordx4 v[64:67], v23, s[48:51], s11 offen offset:0 sc1
    v_mfma_f32_16x16x32_bf16 v[124:127], v[36:39], v[164:167], v[124:127]
    ds_read_b128 v[56:59], v4 offset:10240
    v_mfma_f32_16x16x32_bf16 v[104:107], v[36:39], v[160:163], v[104:107]
    buffer_store_dwordx4 v[68:71], v23, s[48:51], s11 offen offset:512 sc1
    s_nop 1
    v_permlane32_swap_b32 v64, v68
    v_permlane32_swap_b32 v65, v69
    v_permlane32_swap_b32 v66, v70
    v_permlane32_swap_b32 v67, v71
    v_permlane16_swap_b32 v64, v68
    s_waitcnt vmcnt(18) lgkmcnt(0)
    s_barrier
    s_xor_b64 s[16:17], s[16:17], s[0:1]
    s_xor_b64 s[18:19], s[18:19], s[0:1]
    s_or_b64 s[16:17], s[16:17], s[18:19]
    s_cbranch_scc1 L_slow_45
L_back_46:
    s_waitcnt lgkmcnt(3)
    v_mfma_f32_16x16x32_bf16 v[128:131], v[40:43], v[164:167], v[128:131]
    ds_read_b128 v[60:63], v4 offset:11264
    v_mfma_f32_16x16x32_bf16 v[108:111], v[40:43], v[160:163], v[108:111]
    s_add_u32 m0, s9, 16384
    s_add_u32 s12, s12, 16384
    buffer_load_dwordx4 v2, s[48:51], s12 offen offset:0 sc1 lds
    v_permlane16_swap_b32 v65, v69
    v_permlane16_swap_b32 v66, v70
    v_permlane16_swap_b32 v67, v71
    v_mfma_f32_16x16x32_bf16 v[132:135], v[44:47], v[164:167], v[132:135]
    ds_read_b128 v[32:35], v4 offset:12288
    v_mfma_f32_16x16x32_bf16 v[112:115], v[44:47], v[160:163], v[112:115]
    buffer_load_dwordx4 v2, s[48:51], s12 offen offset:1024 sc1 lds
    s_waitcnt vmcnt(14) lgkmcnt(3)
    v_mfma_f32_16x16x32_bf16 v[116:119], v[48:51], v[172:175], v[116:119]
    ds_read_b128 v[36:39], v4 offset:18432
    v_mfma_f32_16x16x32_bf16 v[96:99], v[48:51], v[168:171], v[96:99]
    buffer_load_dwordx4 v2, s[48:51], s12 offen offset:2048 sc1 lds
    v_mfma_f32_16x16x32_bf16 v[120:123], v[52:55], v[172:175], v[120:123]
    ds_read_b128 v[40:43], v4 offset:19456
    v_mfma_f32_16x16x32_bf16 v[100:103], v[52:55], v[168:171], v[100:103]
    buffer_load_dwordx4 v2, s[48:51], s12 offen offset:3072 sc1 lds
    s_waitcnt lgkmcnt(3)
    v_mfma_f32_16x16x32_bf16 v[124:127], v[56:59], v[172:175], v[124:127]
    ds_read_b128 v[44:47], v4 offset:20480
    v_mfma_f32_16x16x32_bf16 v[104:107], v[56:59], v[168:171], v[104:107]
    s_add_u32 s13, s13, 16384
    s_xor_b32 s65, s13, 2048
    buffer_load_dwordx4 v[208:211], v5, s[48:51], s65 offen sc1
    v_mfma_f32_16x16x32_bf16 v[128:131], v[60:63], v[172:175], v[128:131]
    ds_read_b128 v[48:51], v4 offset:21504
    v_mfma_f32_16x16x32_bf16 v[108:111], v[60:63], v[168:171], v[108:111]
    buffer_load_dwordx4 v[212:215], v6, s[48:51], s65 offen sc1
    s_waitcnt lgkmcnt(3)
    v_mfma_f32_16x16x32_bf16 v[132:135], v[32:35], v[172:175], v[132:135]
    ds_read_b128 v[52:55], v4 offset:22528
    v_mfma_f32_16x16x32_bf16 v[112:115], v[32:35], v[168:171], v[112:115]
    s_waitcnt vmcnt(6)
    s_barrier
    s_cmp_lg_u32 s3, 2
    s_cbranch_scc1 L_nf_52
    s_mov_b64 exec, 3
    buffer_store_dword v24, v25, s[48:51], s14 offen offset:512 sc1
    s_mov_b64 exec, -1
L_nf_52:
    s_load_dwordx4 s[16:19], s[48:49], s100 offset:256
    s_waitcnt vmcnt(16)
    v_mfma_f32_16x16x32_bf16 v[116:119], v[36:39], v[180:183], v[116:119]
    ds_read_b128 v[56:59], v4 offset:28672
    v_mfma_f32_16x16x32_bf16 v[96:99], v[36:39], v[176:179], v[96:99]
    s_add_u32 m0, s9, 32768
    s_add_u32 s12, s12, 16384
    buffer_load_dwordx4 v2, s[48:51], s12 offen offset:0 sc1 lds
    s_waitcnt lgkmcnt(3)
    v_mfma_f32_16x16x32_bf16 v[120:123], v[40:43], v[180:183], v[120:123]
    ds_read_b128 v[60:63], v4 offset:29696
    v_mfma_f32_16x16x32_bf16 v[100:103], v[40:43], v[176:179], v[100:103]
    buffer_load_dwordx4 v2, s[48:51], s12 offen offset:1024 sc1 lds
    v_mfma_f32_16x16x32_bf16 v[124:127], v[44:47], v[180:183], v[124:127]
    ds_read_b128 v[32:35], v4 offset:30720
    v_mfma_f32_16x16x32_bf16 v[104:107], v[44:47], v[176:179], v[104:107]
    buffer_load_dwordx4 v2, s[48:51], s12 offen offset:2048 sc1 lds
    s_waitcnt lgkmcnt(3)
    v_mfma_f32_16x16x32_bf16 v[128:131], v[48:51], v[180:183], v[128:131]
    ds_read_b128 v[36:39], v4 offset:31744
    v_mfma_f32_16x16x32_bf16 v[108:111], v[48:51], v[176:179], v[108:111]
    buffer_load_dwordx4 v2, s[48:51], s12 offen offset:3072 sc1 lds
    v_mfma_f32_16x16x32_bf16 v[132:135], v[52:55], v[180:183], v[132:135]
    ds_read_b128 v[40:43], v4 offset:32768
    v_mfma_f32_16x16x32_bf16 v[112:115], v[52:55], v[176:179], v[112:115]
    s_xor_b32 s65, s13, 4096
    buffer_load_dwordx4 v[136:139], v5, s[48:51], s65 offen sc1
    s_waitcnt vmcnt(19) lgkmcnt(3)
    v_mfma_f32_16x16x32_bf16 v[116:119], v[56:59], v[188:191], v[116:119]
    ds_read_b128 v[44:47], v4 offset:38912
    v_mfma_f32_16x16x32_bf16 v[96:99], v[56:59], v[184:187], v[96:99]
    buffer_load_dwordx4 v[140:143], v6, s[48:51], s65 offen sc1
    v_mfma_f32_16x16x32_bf16 v[120:123], v[60:63], v[188:191], v[120:123]
    ds_read_b128 v[48:51], v4 offset:39936
    v_mfma_f32_16x16x32_bf16 v[100:103], v[60:63], v[184:187], v[100:103]
    s_xor_b32 s65, s13, 6144
    buffer_load_dwordx4 v[144:147], v5, s[48:51], s65 offen sc1
    s_waitcnt lgkmcnt(3)
    v_mfma_f32_16x16x32_bf16 v[124:127], v[32:35], v[188:191], v[124:127]
    ds_read_b128 v[52:55], v4 offset:40960
    v_mfma_f32_16x16x32_bf16 v[104:107], v[32:35], v[184:187], v[104:107]
    buffer_load_dwordx4 v[148:151], v6, s[48:51], s65 offen sc1
    v_mfma_f32_16x16x32_bf16 v[128:131], v[36:39], v[188:191], v[128:131]
    ds_read_b128 v[56:59], v4 offset:41984
    v_mfma_f32_16x16x32_bf16 v[108:111], v[36:39], v[184:187], v[108:111]
    s_waitcnt lgkmcnt(3)
    v_mfma_f32_16x16x32_bf16 v[132:135], v[40:43], v[188:191], v[132:135]
    ds_read_b128 v[60:63], v4 offset:43008
    v_mfma_f32_16x16x32_bf16 v[112:115], v[40:43], v[184:187], v[112:115]
    s_waitcnt vmcnt(18) lgkmcnt(0)
    s_barrier
    s_xor_b64 s[16:17], s[16:17], s[0:1]
    s_xor_b64 s[18:19], s[18:19], s[0:1]
    s_or_b64 s[16:17], s[16:17], s[18:19]
    s_cbranch_scc1 L_slow_53
L_back_54:
    s_waitcnt vmcnt(16)
    v_mfma_f32_16x16x32_bf16 v[116:119], v[44:47], v[196:199], v[116:119]
    ds_read_b128 v[32:35], v3 offset:0
    v_mfma_f32_16x16x32_bf16 v[96:99], v[44:47], v[192:195], v[96:99]
    s_add_u32 m0, s9, 49152
    s_add_u32 s12, s12, 16384
    buffer_load_dwordx4 v2, s[48:51], s12 offen offset:0 sc1 lds
    s_waitcnt lgkmcnt(3)
    v_mfma_f32_16x16x32_bf16 v[120:123], v[48:51], v[196:199], v[120:123]
    ds_read_b128 v[36:39], v3 offset:1024
    v_mfma_f32_16x16x32_bf16 v[100:103], v[48:51], v[192:195], v[100:103]
    buffer_load_dwordx4 v2, s[48:51], s12 offen offset:1024 sc1 lds
    v_mfma_f32_16x16x32_bf16 v[124:127], v[52:55], v[196:199], v[124:127]
    ds_read_b128 v[40:43], v3 offset:2048
    v_mfma_f32_16x16x32_bf16 v[104:107], v[52:55], v[192:195], v[104:107]
    buffer_load_dwordx4 v2, s[48:51], s12 offen offset:2048 sc1 lds
    s_waitcnt lgkmcnt(3)
    v_mfma_f32_16x16x32_bf16 v[128:131], v[56:59], v[196:199], v[128:131]
    ds_read_b128 v[44:47], v3 offset:3072
    v_mfma_f32_16x16x32_bf16 v[108:111], v[56:59], v[192:195], v[108:111]
    buffer_load_dwordx4 v2, s[48:51], s12 offen offset:3072 sc1 lds
    v_mfma_f32_16x16x32_bf16 v[132:135], v[60:63], v[196:199], v[132:135]
    ds_read_b128 v[48:51], v3 offset:4096
    v_mfma_f32_16x16x32_bf16 v[112:115], v[60:63], v[192:195], v[112:115]
    s_xor_b32 s65, s13, 8192
    buffer_load_dwordx4 v[152:155], v5, s[48:51], s65 offen sc1
    s_waitcnt lgkmcnt(3)
    v_mfma_f32_16x16x32_bf16 v[116:119], v[32:35], v[84:87], v[116:119]
    ds_read_b128 v[52:55], v3 offset:10240
    v_mfma_f32_16x16x32_bf16 v[96:99], v[32:35], v[80:83], v[96:99]
    buffer_load_dwordx4 v[156:159], v6, s[48:51], s65 offen sc1
    s_waitcnt vmcnt(16)
    s_barrier
    v_mfma_f32_16x16x32_bf16 v[120:123], v[36:39], v[84:87], v[120:123]
    ds_read_b128 v[56:59], v3 offset:11264
    v_mfma_f32_16x16x32_bf16 v[100:103], v[36:39], v[80:83], v[100:103]
    s_xor_b32 s65, s13, 10240
    buffer_load_dwordx4 v[160:163], v5, s[48:51], s65 offen sc1
    s_waitcnt lgkmcnt(3)
    v_mfma_f32_16x16x32_bf16 v[124:127], v[40:43], v[84:87], v[124:127]
    ds_read_b128 v[60:63], v3 offset:12288
    v_mfma_f32_16x16x32_bf16 v[104:107], v[40:43], v[80:83], v[104:107]
    buffer_load_dwordx4 v[164:167], v6, s[48:51], s65 offen sc1
    v_mfma_f32_16x16x32_bf16 v[128:131], v[44:47], v[84:87], v[128:131]
    ds_read_b128 v[32:35], v3 offset:13312
    v_mfma_f32_16x16x32_bf16 v[108:111], v[44:47], v[80:83], v[108:111]
    s_add_u32 m0, s9, 65536
    s_add_u32 s12, s12, 16384
    buffer_load_dwordx4 v2, s[48:51], s12 offen offset:0 sc1 lds
    s_waitcnt lgkmcnt(3)
    v_mfma_f32_16x16x32_bf16 v[132:135], v[48:51], v[84:87], v[132:135]
    ds_read_b128 v[36:39], v3 offset:14336
    v_mfma_f32_16x16x32_bf16 v[112:115], v[48:51], v[80:83], v[112:115]
    buffer_load_dwordx4 v2, s[48:51], s12 offen offset:1024 sc1 lds
    s_waitcnt vmcnt(18)
    v_mfma_f32_16x16x32_bf16 v[116:119], v[52:55], v[212:215], v[116:119]
    ds_read_b128 v[40:43], v3 offset:20480
    v_mfma_f32_16x16x32_bf16 v[96:99], v[52:55], v[208:211], v[96:99]
    buffer_load_dwordx4 v2, s[48:51], s12 offen offset:2048 sc1 lds
    s_waitcnt lgkmcnt(3)
    v_mfma_f32_16x16x32_bf16 v[120:123], v[56:59], v[212:215], v[120:123]
    ds_read_b128 v[44:47], v3 offset:21504
    v_mfma_f32_16x16x32_bf16 v[100:103], v[56:59], v[208:211], v[100:103]
    buffer_load_dwordx4 v2, s[48:51], s12 offen offset:3072 sc1 lds
    v_mfma_f32_16x16x32_bf16 v[124:127], v[60:63], v[212:215], v[124:127]
    ds_read_b128 v[48:51], v3 offset:22528
    v_mfma_f32_16x16x32_bf16 v[104:107], v[60:63], v[208:211], v[104:107]
    s_xor_b32 s65, s13, 12288
    buffer_load_dwordx4 v[168:171], v5, s[48:51], s65 offen sc1
    s_waitcnt lgkmcnt(3)
    v_mfma_f32_16x16x32_bf16 v[128:131], v[32:35], v[212:215], v[128:131]
    ds_read_b128 v[52:55], v3 offset:23552
    v_mfma_f32_16x16x32_bf16 v[108:111], v[32:35], v[208:211], v[108:111]
    buffer_load_dwordx4 v[172:175], v6, s[48:51], s65 offen sc1
    v_mfma_f32_16x16x32_bf16 v[132:135], v[36:39], v[212:215], v[132:135]
    ds_read_b128 v[56:59], v3 offset:24576
    v_mfma_f32_16x16x32_bf16 v[112:115], v[36:39], v[208:211], v[112:115]
    s_waitcnt vmcnt(18)
    s_barrier
    s_load_dwordx4 s[16:19], s[48:49], s15 offset:512
    s_waitcnt vmcnt(16) lgkmcnt(3)
    v_mfma_f32_16x16x32_bf16 v[116:119], v[40:43], v[140:143], v[116:119]
    ds_read_b128 v[60:63], v3 offset:30720
    v_mfma_f32_16x16x32_bf16 v[96:99], v[40:43], v[136:139], v[96:99]
    s_add_u32 m0, s9, 0
    s_add_u32 s12, s12, 16384
    buffer_load_dwordx4 v2, s[48:51], s12 offen offset:0 sc1 lds
    v_mfma_f32_16x16x32_bf16 v[120:123], v[44:47], v[140:143], v[120:123]
    ds_read_b128 v[32:35], v3 offset:31744
    v_mfma_f32_16x16x32_bf16 v[100:103], v[44:47], v[136:139], v[100:103]
    buffer_load_dwordx4 v2, s[48:51], s12 offen offset:1024 sc1 lds
    s_waitcnt lgkmcnt(3)
    v_mfma_f32_16x16x32_bf16 v[124:127], v[48:51], v[140:143], v[124:127]
    ds_read_b128 v[36:39], v4 offset:0
    v_mfma_f32_16x16x32_bf16 v[104:107], v[48:51], v[136:139], v[104:107]
    buffer_load_dwordx4 v2, s[48:51], s12 offen offset:2048 sc1 lds
    v_mfma_f32_16x16x32_bf16 v[128:131], v[52:55], v[140:143], v[128:131]
    ds_read_b128 v[40:43], v4 offset:1024
    v_mfma_f32_16x16x32_bf16 v[108:111], v[52:55], v[136:139], v[108:111]
    buffer_load_dwordx4 v2, s[48:51], s12 offen offset:3072 sc1 lds
    s_waitcnt lgkmcnt(3)
    v_mfma_f32_16x16x32_bf16 v[132:135], v[56:59], v[140:143], v[132:135]
    ds_read_b128 v[44:47], v4 offset:2048
    v_mfma_f32_16x16x32_bf16 v[112:115], v[56:59], v[136:139], v[112:115]
    s_xor_b32 s65, s13, 14336
    buffer_load_dwordx4 v[176:179], v5, s[48:51], s65 offen sc1
    s_waitcnt vmcnt(19)
    v_mfma_f32_16x16x32_bf16 v[116:119], v[60:63], v[148:151], v[116:119]
    ds_read_b128 v[48:51], v4 offset:8192
    v_mfma_f32_16x16x32_bf16 v[96:99], v[60:63], v[144:147], v[96:99]
    buffer_load_dwordx4 v[180:183], v6, s[48:51], s65 offen sc1
    s_waitcnt lgkmcnt(3)
    v_mfma_f32_16x16x32_bf16 v[120:123], v[32:35], v[148:151], v[120:123]
    ds_read_b128 v[52:55], v4 offset:9216
    v_mfma_f32_16x16x32_bf16 v[100:103], v[32:35], v[144:147], v[100:103]
    v_mfma_f32_16x16x32_bf16 v[124:127], v[36:39], v[148:151], v[124:127]
    ds_read_b128 v[56:59], v4 offset:10240
    v_mfma_f32_16x16x32_bf16 v[104:107], v[36:39], v[144:147], v[104:107]
    s_waitcnt vmcnt(16) lgkmcnt(0)
    s_barrier
    s_xor_b64 s[16:17], s[16:17], s[0:1]
    s_xor_b64 s[18:19], s[18:19], s[0:1]
    s_or_b64 s[16:17], s[16:17], s[18:19]
    s_cbranch_scc1 L_slow_60
L_back_61:
    s_waitcnt lgkmcnt(3)
    v_mfma_f32_16x16x32_bf16 v[128:131], v[40:43], v[148:151], v[128:131]
    ds_read_b128 v[60:63], v4 offset:11264
    v_mfma_f32_16x16x32_bf16 v[108:111], v[40:43], v[144:147], v[108:111]
    s_add_u32 m0, s9, 16384
    s_add_u32 s12, s12, 16384
    buffer_load_dwordx4 v2, s[48:51], s12 offen offset:0 sc1 lds
    v_mfma_f32_16x16x32_bf16 v[132:135], v[44:47], v[148:151], v[132:135]
    ds_read_b128 v[32:35], v4 offset:12288
    v_mfma_f32_16x16x32_bf16 v[112:115], v[44:47], v[144:147], v[112:115]
    buffer_load_dwordx4 v2, s[48:51], s12 offen offset:1024 sc1 lds
    s_waitcnt vmcnt(16) lgkmcnt(3)
    v_mfma_f32_16x16x32_bf16 v[116:119], v[48:51], v[156:159], v[116:119]
    ds_read_b128 v[36:39], v4 offset:18432
    v_mfma_f32_16x16x32_bf16 v[96:99], v[48:51], v[152:155], v[96:99]
    buffer_load_dwordx4 v2, s[48:51], s12 offen offset:2048 sc1 lds
    v_mfma_f32_16x16x32_bf16 v[120:123], v[52:55], v[156:159], v[120:123]
    ds_read_b128 v[40:43], v4 offset:19456
    v_mfma_f32_16x16x32_bf16 v[100:103], v[52:55], v[152:155], v[100:103]
    buffer_load_dwordx4 v2, s[48:51], s12 offen offset:3072 sc1 lds
    s_waitcnt lgkmcnt(3)
    v_mfma_f32_16x16x32_bf16 v[124:127], v[56:59], v[156:159], v[124:127]
    ds_read_b128 v[44:47], v4 offset:20480
    v_mfma_f32_16x16x32_bf16 v[104:107], v[56:59], v[152:155], v[104:107]
    s_add_u32 s13, s13, 16384
    s_xor_b32 s65, s13, 2048
    buffer_load_dwordx4 v[192:195], v5, s[48:51], s65 offen sc1
    v_mfma_f32_16x16x32_bf16 v[128:131], v[60:63], v[156:159], v[128:131]
    ds_read_b128 v[48:51], v4 offset:21504
    v_mfma_f32_16x16x32_bf16 v[108:111], v[60:63], v[152:155], v[108:111]
    buffer_load_dwordx4 v[196:199], v6, s[48:51], s65 offen sc1
    s_waitcnt lgkmcnt(3)
    v_mfma_f32_16x16x32_bf16 v[132:135], v[32:35], v[156:159], v[132:135]
    ds_read_b128 v[52:55], v4 offset:22528
    v_mfma_f32_16x16x32_bf16 v[112:115], v[32:35], v[152:155], v[112:115]
    s_waitcnt vmcnt(14)
    s_barrier
    s_load_dwordx4 s[16:19], s[48:49], s100 offset:512
    s_waitcnt vmcnt(18)
    v_mfma_f32_16x16x32_bf16 v[116:119], v[36:39], v[164:167], v[116:119]
    ds_read_b128 v[56:59], v4 offset:28672
    v_mfma_f32_16x16x32_bf16 v[96:99], v[36:39], v[160:163], v[96:99]
    s_add_u32 m0, s9, 32768
    s_add_u32 s12, s12, 16384
    buffer_load_dwordx4 v2, s[48:51], s12 offen offset:0 sc1 lds
    s_waitcnt lgkmcnt(3)
    v_mfma_f32_16x16x32_bf16 v[120:123], v[40:43], v[164:167], v[120:123]
    ds_read_b128 v[60:63], v4 offset:29696
    v_mfma_f32_16x16x32_bf16 v[100:103], v[40:43], v[160:163], v[100:103]
    buffer_load_dwordx4 v2, s[48:51], s12 offen offset:1024 sc1 lds
    v_mfma_f32_16x16x32_bf16 v[124:127], v[44:47], v[164:167], v[124:127]
    ds_read_b128 v[32:35], v4 offset:30720
    v_mfma_f32_16x16x32_bf16 v[104:107], v[44:47], v[160:163], v[104:107]
    buffer_load_dwordx4 v2, s[48:51], s12 offen offset:2048 sc1 lds
    s_waitcnt lgkmcnt(3)
    v_mfma_f32_16x16x32_bf16 v[128:131], v[48:51], v[164:167], v[128:131]
    ds_read_b128 v[36:39], v4 offset:31744
    v_mfma_f32_16x16x32_bf16 v[108:111], v[48:51], v[160:163], v[108:111]
    buffer_load_dwordx4 v2, s[48:51], s12 offen offset:3072 sc1 lds
    v_mfma_f32_16x16x32_bf16 v[132:135], v[52:55], v[164:167], v[132:135]
    ds_read_b128 v[40:43], v4 offset:32768
    v_mfma_f32_16x16x32_bf16 v[112:115], v[52:55], v[160:163], v[112:115]
    s_xor_b32 s65, s13, 4096
    buffer_load_dwordx4 v[200:203], v5, s[48:51], s65 offen sc1
    s_waitcnt vmcnt(17) lgkmcnt(3)
    v_mfma_f32_16x16x32_bf16 v[116:119], v[56:59], v[172:175], v[116:119]
    ds_read_b128 v[44:47], v4 offset:38912
    v_mfma_f32_16x16x32_bf16 v[96:99], v[56:59], v[168:171], v[96:99]
    buffer_load_dwordx4 v[204:207], v6, s[48:51], s65 offen sc1
    v_mfma_f32_16x16x32_bf16 v[120:123], v[60:63], v[172:175], v[120:123]
    ds_read_b128 v[48:51], v4 offset:39936
    v_mfma_f32_16x16x32_bf16 v[100:103], v[60:63], v[168:171], v[100:103]
    s_xor_b32 s65, s13, 6144
    buffer_load_dwordx4 v[208:211], v5, s[48:51], s65 offen sc1
    s_waitcnt lgkmcnt(3)
    v_mfma_f32_16x16x32_bf16 v[124:127], v[32:35], v[172:175], v[124:127]
    ds_read_b128 v[52:55], v4 offset:40960
    v_mfma_f32_16x16x32_bf16 v[104:107], v[32:35], v[168:171], v[104:107]
    buffer_load_dwordx4 v[212:215], v6, s[48:51], s65 offen sc1
    v_mfma_f32_16x16x32_bf16 v[128:131], v[36:39], v[172:175], v[128:131]
    ds_read_b128 v[56:59], v4 offset:41984
    v_mfma_f32_16x16x32_bf16 v[108:111], v[36:39], v[168:171], v[108:111]
    s_waitcnt lgkmcnt(3)
    v_mfma_f32_16x16x32_bf16 v[132:135], v[40:43], v[172:175], v[132:135]
    ds_read_b128 v[60:63], v4 offset:43008
    v_mfma_f32_16x16x32_bf16 v[112:115], v[40:43], v[168:171], v[112:115]
    s_waitcnt vmcnt(16) lgkmcnt(0)
    s_barrier
    s_xor_b64 s[16:17], s[16:17], s[0:1]
    s_xor_b64 s[18:19], s[18:19], s[0:1]
    s_or_b64 s[16:17], s[16:17], s[18:19]
    s_cbranch_scc1 L_slow_67
L_back_68:
    s_waitcnt vmcnt(14)
    v_mfma_f32_16x16x32_bf16 v[116:119], v[44:47], v[180:183], v[116:119]
    ds_read_b128 v[32:35], v3 offset:0
    v_mfma_f32_16x16x32_bf16 v[96:99], v[44:47], v[176:179], v[96:99]
    s_add_u32 m0, s9, 49152
    s_add_u32 s12, s12, 16384
    buffer_load_dwordx4 v2, s[48:51], s12 offen offset:0 sc1 lds
    s_waitcnt lgkmcnt(3)
    v_mfma_f32_16x16x32_bf16 v[120:123], v[48:51], v[180:183], v[120:123]
    ds_read_b128 v[36:39], v3 offset:1024
    v_mfma_f32_16x16x32_bf16 v[100:103], v[48:51], v[176:179], v[100:103]
    buffer_load_dwordx4 v2, s[48:51], s12 offen offset:1024 sc1 lds
    v_mfma_f32_16x16x32_bf16 v[124:127], v[52:55], v[180:183], v[124:127]
    ds_read_b128 v[40:43], v3 offset:2048
    v_mfma_f32_16x16x32_bf16 v[104:107], v[52:55], v[176:179], v[104:107]
    buffer_load_dwordx4 v2, s[48:51], s12 offen offset:2048 sc1 lds
    s_waitcnt lgkmcnt(3)
    v_mfma_f32_16x16x32_bf16 v[128:131], v[56:59], v[180:183], v[128:131]
    ds_read_b128 v[44:47], v3 offset:3072
    v_mfma_f32_16x16x32_bf16 v[108:111], v[56:59], v[176:179], v[108:111]
    buffer_load_dwordx4 v2, s[48:51], s12 offen offset:3072 sc1 lds
    v_mfma_f32_16x16x32_bf16 v[132:135], v[60:63], v[180:183], v[132:135]
    ds_read_b128 v[48:51], v3 offset:4096
    v_mfma_f32_16x16x32_bf16 v[112:115], v[60:63], v[176:179], v[112:115]
    s_xor_b32 s65, s13, 8192
    buffer_load_dwordx4 v[136:139], v5, s[48:51], s65 offen sc1
    s_waitcnt lgkmcnt(3)
    v_mfma_f32_16x16x32_bf16 v[116:119], v[32:35], v[68:71], v[116:119]
    ds_read_b128 v[52:55], v3 offset:10240
    v_mfma_f32_16x16x32_bf16 v[96:99], v[32:35], v[64:67], v[96:99]
    buffer_load_dwordx4 v[140:143], v6, s[48:51], s65 offen sc1
    s_waitcnt vmcnt(16)
    s_barrier
    buffer_load_dword v1, v9, s[48:51], s4 offen sc1
    v_mfma_f32_16x16x32_bf16 v[120:123], v[36:39], v[68:71], v[120:123]
    ds_read_b128 v[56:59], v3 offset:11264
    v_mfma_f32_16x16x32_bf16 v[100:103], v[36:39], v[64:67], v[100:103]
    buffer_load_dwordx2 v[30:31], v11, s[48:51], s10 offen sc1
    s_waitcnt lgkmcnt(3)
    v_mfma_f32_16x16x32_bf16 v[124:127], v[40:43], v[68:71], v[124:127]
    ds_read_b128 v[60:63], v3 offset:12288
    v_mfma_f32_16x16x32_bf16 v[104:107], v[40:43], v[64:67], v[104:107]
    s_xor_b32 s65, s13, 10240
    buffer_load_dwordx4 v[144:147], v5, s[48:51], s65 offen sc1
    v_mfma_f32_16x16x32_bf16 v[128:131], v[44:47], v[68:71], v[128:131]
    ds_read_b128 v[32:35], v3 offset:13312
    v_mfma_f32_16x16x32_bf16 v[108:111], v[44:47], v[64:67], v[108:111]
    buffer_load_dwordx4 v[148:151], v6, s[48:51], s65 offen sc1
    s_waitcnt lgkmcnt(3)
    v_mfma_f32_16x16x32_bf16 v[132:135], v[48:51], v[68:71], v[132:135]
    ds_read_b128 v[36:39], v3 offset:14336
    v_mfma_f32_16x16x32_bf16 v[112:115], v[48:51], v[64:67], v[112:115]
    s_add_u32 m0, s9, 65536
    s_add_u32 s12, s12, 16384
    buffer_load_dwordx4 v2, s[48:51], s12 offen offset:0 sc1 lds
    s_waitcnt vmcnt(19)
    v_mfma_f32_16x16x32_bf16 v[116:119], v[52:55], v[196:199], v[116:119]
    ds_read_b128 v[40:43], v3 offset:20480
    v_mfma_f32_16x16x32_bf16 v[96:99], v[52:55], v[192:195], v[96:99]
    buffer_load_dwordx4 v2, s[48:51], s12 offen offset:1024 sc1 lds
    s_waitcnt lgkmcnt(3)
    v_mfma_f32_16x16x32_bf16 v[120:123], v[56:59], v[196:199], v[120:123]
    ds_read_b128 v[44:47], v3 offset:21504
    v_mfma_f32_16x16x32_bf16 v[100:103], v[56:59], v[192:195], v[100:103]
    buffer_load_dwordx4 v2, s[48:51], s12 offen offset:2048 sc1 lds
    v_mfma_f32_16x16x32_bf16 v[124:127], v[60:63], v[196:199], v[124:127]
    ds_read_b128 v[48:51], v3 offset:22528
    v_mfma_f32_16x16x32_bf16 v[104:107], v[60:63], v[192:195], v[104:107]
    buffer_load_dwordx4 v2, s[48:51], s12 offen offset:3072 sc1 lds
    s_waitcnt lgkmcnt(3)
    v_mfma_f32_16x16x32_bf16 v[128:131], v[32:35], v[196:199], v[128:131]
    ds_read_b128 v[52:55], v3 offset:23552
    v_mfma_f32_16x16x32_bf16 v[108:111], v[32:35], v[192:195], v[108:111]
    s_xor_b32 s65, s13, 12288
    buffer_load_dwordx4 v[152:155], v5, s[48:51], s65 offen sc1
    v_mfma_f32_16x16x32_bf16 v[132:135], v[36:39], v[196:199], v[132:135]
    ds_read_b128 v[56:59], v3 offset:24576
    v_mfma_f32_16x16x32_bf16 v[112:115], v[36:39], v[192:195], v[112:115]
    buffer_load_dwordx4 v[156:159], v6, s[48:51], s65 offen sc1
    s_waitcnt vmcnt(20)
    s_barrier
    s_waitcnt vmcnt(18) lgkmcnt(3)
    v_mfma_f32_16x16x32_bf16 v[116:119], v[40:43], v[204:207], v[116:119]
    ds_read_b128 v[60:63], v3 offset:30720
    v_mfma_f32_16x16x32_bf16 v[96:99], v[40:43], v[200:203], v[96:99]
    s_xor_b32 s65, s13, 14336
    buffer_load_dwordx4 v[160:163], v5, s[48:51], s65 offen sc1
    v_mfma_f32_16x16x32_bf16 v[120:123], v[44:47], v[204:207], v[120:123]
    ds_read_b128 v[32:35], v3 offset:31744
    v_mfma_f32_16x16x32_bf16 v[100:103], v[44:47], v[200:203], v[100:103]
    buffer_load_dwordx4 v[164:167], v6, s[48:51], s65 offen sc1
    s_waitcnt lgkmcnt(3)
    v_mfma_f32_16x16x32_bf16 v[124:127], v[48:51], v[204:207], v[124:127]
    ds_read_b128 v[36:39], v4 offset:0
    v_mfma_f32_16x16x32_bf16 v[104:107], v[48:51], v[200:203], v[104:107]
    v_mfma_f32_16x16x32_bf16 v[128:131], v[52:55], v[204:207], v[128:131]
    ds_read_b128 v[40:43], v4 offset:1024
    v_mfma_f32_16x16x32_bf16 v[108:111], v[52:55], v[200:203], v[108:111]
    s_waitcnt lgkmcnt(3)
    v_mfma_f32_16x16x32_bf16 v[132:135], v[56:59], v[204:207], v[132:135]
    ds_read_b128 v[44:47], v4 offset:2048
    v_mfma_f32_16x16x32_bf16 v[112:115], v[56:59], v[200:203], v[112:115]
    s_waitcnt vmcnt(18)
    v_mfma_f32_16x16x32_bf16 v[116:119], v[60:63], v[212:215], v[116:119]
    ds_read_b128 v[48:51], v4 offset:8192
    v_mfma_f32_16x16x32_bf16 v[96:99], v[60:63], v[208:211], v[96:99]
    s_waitcnt lgkmcnt(3)
    v_mfma_f32_16x16x32_bf16 v[120:123], v[32:35], v[212:215], v[120:123]
    ds_read_b128 v[52:55], v4 offset:9216
    v_mfma_f32_16x16x32_bf16 v[100:103], v[32:35], v[208:211], v[100:103]
    v_mfma_f32_16x16x32_bf16 v[124:127], v[36:39], v[212:215], v[124:127]
    ds_read_b128 v[56:59], v4 offset:10240
    v_mfma_f32_16x16x32_bf16 v[104:107], v[36:39], v[208:211], v[104:107]
    s_waitcnt vmcnt(11)
    s_barrier
    v_cmp_ne_u32 vcc, s7, v1
    s_nop 0
    s_cmp_eq_u64 vcc, 0
    s_cselect_b32 s43, 1, 0
    s_cselect_b32 s64, s42, s12
    buffer_load_dword v1, v9, s[48:51], s4 offen sc1
    s_add_u32 m0, s9, 0
    s_nop 0
    buffer_load_dwordx4 v10, s[48:51], s64 offen sc1 lds
    s_add_u32 s67, s64, 131072
    s_add_u32 m0, s9, 1024
    s_nop 0
    buffer_load_dwordx4 v10, s[48:51], s67 offen sc1 lds
    s_lshl_b32 s67, s47, 8
    s_add_u32 s67, s67, s64
    s_add_u32 m0, s9, 2048
    s_nop 0
    buffer_load_dwordx4 v10, s[48:51], s67 offen sc1 lds
    s_waitcnt vmcnt(14)
    v_cmp_ne_u32 vcc, s7, v31
    s_nop 0
    s_cmp_eq_u64 vcc, 0
    s_cbranch_scc0 L_slow_74
L_back_75:
    s_waitcnt lgkmcnt(3)
    v_mfma_f32_16x16x32_bf16 v[128:131], v[40:43], v[212:215], v[128:131]
    ds_read_b128 v[60:63], v4 offset:11264
    v_mfma_f32_16x16x32_bf16 v[108:111], v[40:43], v[208:211], v[108:111]
    v_sub_f32 v28, 1.0, v30
    v_cvt_pk_bf16_f32 v28, v28, v28
    v_lshlrev_b32 v28, 16, v28
    v_mov_b32 v29, v28
    v_mov_b32 v31, v30
    v_xor_b32 v8, 0x2000, v2
    v_mfma_f32_16x16x32_bf16 v[132:135], v[44:47], v[212:215], v[132:135]
    ds_read_b128 v[32:35], v4 offset:12288
    v_mfma_f32_16x16x32_bf16 v[112:115], v[44:47], v[208:211], v[112:115]
    s_waitcnt vmcnt(16) lgkmcnt(3)
    v_mfma_f32_16x16x32_bf16 v[116:119], v[48:51], v[140:143], v[116:119]
    ds_read_b128 v[36:39], v4 offset:18432
    v_mfma_f32_16x16x32_bf16 v[96:99], v[48:51], v[136:139], v[96:99]
    v_mfma_f32_16x16x32_bf16 v[120:123], v[52:55], v[140:143], v[120:123]
    ds_read_b128 v[40:43], v4 offset:19456
    v_mfma_f32_16x16x32_bf16 v[100:103], v[52:55], v[136:139], v[100:103]
    s_waitcnt lgkmcnt(3)
    v_mfma_f32_16x16x32_bf16 v[124:127], v[56:59], v[140:143], v[124:127]
    ds_read_b128 v[44:47], v4 offset:20480
    v_mfma_f32_16x16x32_bf16 v[104:107], v[56:59], v[136:139], v[104:107]
    v_mfma_f32_16x16x32_bf16 v[128:131], v[60:63], v[140:143], v[128:131]
    ds_read_b128 v[48:51], v4 offset:21504
    v_mfma_f32_16x16x32_bf16 v[108:111], v[60:63], v[136:139], v[108:111]
    s_waitcnt lgkmcnt(3)
    v_mfma_f32_16x16x32_bf16 v[132:135], v[32:35], v[140:143], v[132:135]
    ds_read_b128 v[52:55], v4 offset:22528
    v_mfma_f32_16x16x32_bf16 v[112:115], v[32:35], v[136:139], v[112:115]
    s_waitcnt vmcnt(8)
    s_barrier
    s_cmp_lg_u32 s43, 0
    s_cbranch_scc0 L_slow_78
L_back_79:
    s_waitcnt vmcnt(12)
    v_mfma_f32_16x16x32_bf16 v[116:119], v[36:39], v[148:151], v[116:119]
    ds_read_b128 v[56:59], v4 offset:28672
    v_mfma_f32_16x16x32_bf16 v[96:99], v[36:39], v[144:147], v[96:99]
    s_waitcnt lgkmcnt(3)
    v_mfma_f32_16x16x32_bf16 v[120:123], v[40:43], v[148:151], v[120:123]
    ds_read_b128 v[60:63], v4 offset:29696
    v_mfma_f32_16x16x32_bf16 v[100:103], v[40:43], v[144:147], v[100:103]
    v_mfma_f32_16x16x32_bf16 v[124:127], v[44:47], v[148:151], v[124:127]
    ds_read_b128 v[32:35], v4 offset:30720
    v_mfma_f32_16x16x32_bf16 v[104:107], v[44:47], v[144:147], v[104:107]
    s_waitcnt lgkmcnt(3)
    v_mfma_f32_16x16x32_bf16 v[128:131], v[48:51], v[148:151], v[128:131]
    ds_read_b128 v[36:39], v4 offset:31744
    v_mfma_f32_16x16x32_bf16 v[108:111], v[48:51], v[144:147], v[108:111]
    v_mfma_f32_16x16x32_bf16 v[132:135], v[52:55], v[148:151], v[132:135]
    ds_read_b128 v[40:43], v4 offset:32768
    v_mfma_f32_16x16x32_bf16 v[112:115], v[52:55], v[144:147], v[112:115]
    s_waitcnt vmcnt(6) lgkmcnt(3)
    v_mfma_f32_16x16x32_bf16 v[116:119], v[56:59], v[156:159], v[116:119]
    ds_read_b128 v[44:47], v4 offset:38912
    v_mfma_f32_16x16x32_bf16 v[96:99], v[56:59], v[152:155], v[96:99]
    v_mfma_f32_16x16x32_bf16 v[120:123], v[60:63], v[156:159], v[120:123]
    ds_read_b128 v[48:51], v4 offset:39936
    v_mfma_f32_16x16x32_bf16 v[100:103], v[60:63], v[152:155], v[100:103]
    s_waitcnt lgkmcnt(3)
    v_mfma_f32_16x16x32_bf16 v[124:127], v[32:35], v[156:159], v[124:127]
    ds_read_b128 v[52:55], v4 offset:40960
    v_mfma_f32_16x16x32_bf16 v[104:107], v[32:35], v[152:155], v[104:107]
    v_mfma_f32_16x16x32_bf16 v[128:131], v[36:39], v[156:159], v[128:131]
    ds_read_b128 v[56:59], v4 offset:41984
    v_mfma_f32_16x16x32_bf16 v[108:111], v[36:39], v[152:155], v[108:111]
    s_waitcnt lgkmcnt(3)
    v_mfma_f32_16x16x32_bf16 v[132:135], v[40:43], v[156:159], v[132:135]
    ds_read_b128 v[60:63], v4 offset:43008
    v_mfma_f32_16x16x32_bf16 v[112:115], v[40:43], v[152:155], v[112:115]
    s_waitcnt vmcnt(4)
    v_mfma_f32_16x16x32_bf16 v[116:119], v[44:47], v[164:167], v[116:119]
    s_waitcnt lgkmcnt(2)
    v_mfma_f32_16x16x32_bf16 v[120:123], v[48:51], v[164:167], v[120:123]
    v_mfma_f32_16x16x32_bf16 v[124:127], v[52:55], v[164:167], v[124:127]
    s_waitcnt lgkmcnt(0)
    v_mfma_f32_16x16x32_bf16 v[128:131], v[56:59], v[164:167], v[128:131]
    v_mfma_f32_16x16x32_bf16 v[132:135], v[60:63], v[164:167], v[132:135]
    v_mfma_f32_16x16x32_bf16 v[96:99], v[44:47], v[160:163], v[96:99]
    v_mfma_f32_16x16x32_bf16 v[100:103], v[48:51], v[160:163], v[100:103]
    v_mfma_f32_16x16x32_bf16 v[104:107], v[52:55], v[160:163], v[104:107]
    ds_write_b128 v2, v[116:119] offset:16384
    v_mfma_f32_16x16x32_bf16 v[108:111], v[56:59], v[160:163], v[108:111]
    ds_write_b128 v2, v[120:123] offset:17408
    v_mfma_f32_16x16x32_bf16 v[112:115], v[60:63], v[160:163], v[112:115]
    ds_write_b128 v2, v[124:127] offset:18432
    ds_write_b128 v2, v[128:131] offset:19456
    ds_write_b128 v2, v[132:135] offset:3072
    s_cmp_lg_u32 s43, 0
    s_cbranch_scc0 L_slow_81
L_back_82:
    s_waitcnt vmcnt(0) lgkmcnt(0)
    s_barrier
    ds_read_b64_tr_b16 v[64:65], v12 offset:0
    ds_read_b64_tr_b16 v[66:67], v12 offset:8192
    ds_read_b64_tr_b16 v[68:69], v12 offset:1024
    ds_read_b64_tr_b16 v[70:71], v12 offset:9216
    ds_read_b64_tr_b16 v[72:73], v12 offset:2048
    ds_read_b128 v[136:139], v8 offset:16384
    ds_read_b128 v[140:143], v8 offset:17408
    ds_read_b128 v[144:147], v8 offset:18432
    ds_read_b128 v[148:151], v8 offset:19456
    ds_read_b128 v[152:155], v8 offset:3072
    s_waitcnt lgkmcnt(5)
    v_lshlrev_b32 v244, 16, v64
    v_and_b32 v245, 0xffff0000, v64
    v_lshlrev_b32 v246, 16, v65
    v_and_b32 v247, 0xffff0000, v65
    v_lshlrev_b32 v248, 16, v66
    v_and_b32 v249, 0xffff0000, v66
    v_lshlrev_b32 v250, 16, v67
    v_and_b32 v251, 0xffff0000, v67
    v_lshlrev_b32 v252, 16, v68
    v_and_b32 v253, 0xffff0000, v68
    v_lshlrev_b32 v254, 16, v69
    v_and_b32 v255, 0xffff0000, v69
    v_lshlrev_b32 v84, 16, v70
    v_and_b32 v85, 0xffff0000, v70
    v_lshlrev_b32 v86, 16, v71
    v_and_b32 v87, 0xffff0000, v71
    v_lshlrev_b32 v88, 16, v72
    v_and_b32 v89, 0xffff0000, v72
    v_lshlrev_b32 v90, 16, v73
    v_and_b32 v91, 0xffff0000, v73
    s_waitcnt lgkmcnt(4)
    v_pk_add_f32 v[96:97], v[96:97], v[136:137]
    v_pk_mul_f32 v[96:97], v[96:97], v[28:29]
    v_pk_fma_f32 v[96:97], v[244:245], v[30:31], v[96:97]
    v_cvt_pk_bf16_f32 v64, v96, v97
    v_pk_add_f32 v[98:99], v[98:99], v[138:139]
    v_pk_mul_f32 v[98:99], v[98:99], v[28:29]
    v_pk_fma_f32 v[98:99], v[246:247], v[30:31], v[98:99]
    v_cvt_pk_bf16_f32 v65, v98, v99
    ds_write_b64 v13, v[64:65] offset:32768
    s_waitcnt lgkmcnt(4)
    v_pk_add_f32 v[100:101], v[100:101], v[140:141]
    v_pk_mul_f32 v[100:101], v[100:101], v[28:29]
    v_pk_fma_f32 v[100:101], v[248:249], v[30:31], v[100:101]
    v_cvt_pk_bf16_f32 v66, v100, v101
    v_pk_add_f32 v[102:103], v[102:103], v[142:143]
    v_pk_mul_f32 v[102:103], v[102:103], v[28:29]
    v_pk_fma_f32 v[102:103], v[250:251], v[30:31], v[102:103]
    v_cvt_pk_bf16_f32 v67, v102, v103
    ds_write_b64 v13, v[66:67] offset:32800
    s_waitcnt lgkmcnt(4)
    v_pk_add_f32 v[104:105], v[104:105], v[144:145]
    v_pk_mul_f32 v[104:105], v[104:105], v[28:29]
    v_pk_fma_f32 v[104:105], v[252:253], v[30:31], v[104:105]
    v_cvt_pk_bf16_f32 v68, v104, v105
    v_pk_add_f32 v[106:107], v[106:107], v[146:147]
    v_pk_mul_f32 v[106:107], v[106:107], v[28:29]
    v_pk_fma_f32 v[106:107], v[254:255], v[30:31], v[106:107]
    v_cvt_pk_bf16_f32 v69, v106, v107
    ds_write_b64 v13, v[68:69] offset:32832
    s_waitcnt lgkmcnt(4)
    v_pk_add_f32 v[108:109], v[108:109], v[148:149]
    v_pk_mul_f32 v[108:109], v[108:109], v[28:29]
    v_pk_fma_f32 v[108:109], v[84:85], v[30:31], v[108:109]
    v_cvt_pk_bf16_f32 v70, v108, v109
    v_pk_add_f32 v[110:111], v[110:111], v[150:151]
    v_pk_mul_f32 v[110:111], v[110:111], v[28:29]
    v_pk_fma_f32 v[110:111], v[86:87], v[30:31], v[110:111]
    v_cvt_pk_bf16_f32 v71, v110, v111
    ds_write_b64 v13, v[70:71] offset:32864
    s_waitcnt lgkmcnt(4)
    v_pk_add_f32 v[112:113], v[112:113], v[152:153]
    v_pk_mul_f32 v[112:113], v[112:113], v[28:29]
    v_pk_fma_f32 v[112:113], v[88:89], v[30:31], v[112:113]
    v_cvt_pk_bf16_f32 v72, v112, v113
    v_pk_add_f32 v[114:115], v[114:115], v[154:155]
    v_pk_mul_f32 v[114:115], v[114:115], v[28:29]
    v_pk_fma_f32 v[114:115], v[90:91], v[30:31], v[114:115]
    v_cvt_pk_bf16_f32 v73, v114, v115
    ds_write_b64 v13, v[72:73] offset:32896
    ds_read_b128 v[200:203], v2 offset:32768
    ds_read_b128 v[204:207], v2 offset:33792
    ds_read_b128 v[208:211], v2 offset:34816
    s_waitcnt lgkmcnt(2)
    buffer_store_dwordx4 v[200:203], v14, s[60:63], s46 offen sc1
    s_waitcnt lgkmcnt(1)
    buffer_store_dwordx4 v[204:207], v15, s[60:63], s46 offen sc1
    s_waitcnt lgkmcnt(0)
    s_mov_b32 exec_hi, 0
    buffer_store_dwordx4 v[208:211], v16, s[60:63], s46 offen sc1
    s_mov_b64 exec, -1
    s_endpgm
L_end:
    s_endpgm
L_slow_1:
    s_load_dword s7, s[44:45], 64
    s_waitcnt lgkmcnt(0)
    s_cmp_lg_u32 s7, 0
    s_cbranch_scc1 L_sn_ok_3
    s_load_dword s7, s[44:45], 128
    s_waitcnt lgkmcnt(0)
    s_cmp_lg_u32 s7, 0
    s_cbranch_scc1 L_sn_ok_3
    s_load_dword s7, s[44:45], 192
    s_waitcnt lgkmcnt(0)
    s_cmp_lg_u32 s7, 0
    s_cbranch_scc1 L_sn_ok_3
    v_mov_b32 v8, 0
    s_mov_b32 s8, 0x100000
    s_branch L_nonce_chk_6
L_nonce_4:
    v_mov_b32 v9, 0
    global_load_dword v8, v9, s[44:45] sc1
    s_waitcnt vmcnt(0)
L_nonce_chk_6:
    v_readfirstlane_b32 s7, v8
    s_nop 0
    s_cmp_lg_u32 s7, 0
    s_cbranch_scc1 L_nonce_ok_5
    s_sleep 2
    s_sub_u32 s8, s8, 1
    s_cmp_lg_u32 s8, 0
    s_cbranch_scc1 L_nonce_4
L_nonce_ok_5:
L_sn_ok_3:
    s_nop 4
    s_branch L_back_2
L_slow_12:
    s_load_dword s7, s[44:45], 64
    s_waitcnt lgkmcnt(0)
    s_cmp_lg_u32 s7, 0
    s_cbranch_scc1 L_sn_ok_14
    s_load_dword s7, s[44:45], 128
    s_waitcnt lgkmcnt(0)
    s_cmp_lg_u32 s7, 0
    s_cbranch_scc1 L_sn_ok_14
    s_load_dword s7, s[44:45], 192
    s_waitcnt lgkmcnt(0)
    s_cmp_lg_u32 s7, 0
    s_cbranch_scc1 L_sn_ok_14
    v_mov_b32 v104, 0
    s_mov_b32 s8, 0x100000
    s_branch L_nonce_chk_17
L_nonce_15:
    v_mov_b32 v105, 0
    global_load_dword v104, v105, s[44:45] sc1
    s_waitcnt vmcnt(0)
L_nonce_chk_17:
    v_readfirstlane_b32 s7, v104
    s_nop 0
    s_cmp_lg_u32 s7, 0
    s_cbranch_scc1 L_nonce_ok_16
    s_sleep 2
    s_sub_u32 s8, s8, 1
    s_cmp_lg_u32 s8, 0
    s_cbranch_scc1 L_nonce_15
L_nonce_ok_16:
L_sn_ok_14:
    s_nop 4
    s_branch L_back_13
L_slow_19:
    s_load_dword s7, s[44:45], 64
    s_waitcnt lgkmcnt(0)
    s_cmp_lg_u32 s7, 0
    s_cbranch_scc1 L_sn_ok_21
    s_load_dword s7, s[44:45], 128
    s_waitcnt lgkmcnt(0)
    s_cmp_lg_u32 s7, 0
    s_cbranch_scc1 L_sn_ok_21
    s_load_dword s7, s[44:45], 192
    s_waitcnt lgkmcnt(0)
    s_cmp_lg_u32 s7, 0
    s_cbranch_scc1 L_sn_ok_21
    v_mov_b32 v1, 0
    s_mov_b32 s8, 0x100000
    s_branch L_nonce_chk_24
L_nonce_22:
    v_mov_b32 v24, 0
    global_load_dword v1, v24, s[44:45] sc1
    s_waitcnt vmcnt(0)
L_nonce_chk_24:
    v_readfirstlane_b32 s7, v1
    s_nop 0
    s_cmp_lg_u32 s7, 0
    s_cbranch_scc1 L_nonce_ok_23
    s_sleep 2
    s_sub_u32 s8, s8, 1
    s_cmp_lg_u32 s8, 0
    s_cbranch_scc1 L_nonce_22
L_nonce_ok_23:
L_sn_ok_21:
    s_nop 4
    s_branch L_back_20
L_slow_26:
    s_mov_b32 s8, 0x100000
    s_mov_b64 vcc, -1
L_poll_28:
    s_mov_b64 exec, vcc
    buffer_load_dword v1, v8, s[48:51], s41 offen sc1
    s_mov_b64 exec, -1
    s_waitcnt vmcnt(0)
    v_cmp_ne_u32 vcc, s7, v1
    s_nop 0
    s_cmp_eq_u64 vcc, 0
    s_cbranch_scc1 L_poll_ok_29
    s_sleep 2
    s_sub_u32 s8, s8, 1
    s_cmp_lg_u32 s8, 0
    s_cbranch_scc1 L_poll_28
L_poll_ok_29:
    s_nop 4
    s_branch L_back_27
L_slow_30:
    s_add_u32 s26, s15, 0
    s_add_u32 s24, s26, 65536
    s_add_u32 s25, s26, 131072
L_sp_32:
    s_cmp_ge_u32 s24, s25
    s_cbranch_scc1 L_sp_fb_34
    s_load_dwordx4 s[16:19], s[48:49], s24
    s_add_u32 s24, s24, 65536
    s_waitcnt lgkmcnt(0)
    s_xor_b64 s[16:17], s[16:17], s[0:1]
    s_xor_b64 s[18:19], s[18:19], s[0:1]
    s_or_b64 s[16:17], s[16:17], s[18:19]
    s_cbranch_scc0 L_sp_ok_33
    s_branch L_sp_32
L_sp_fb_34:
    s_mov_b32 s8, 0x100000
    s_mov_b64 vcc, -1
L_poll_35:
    s_mov_b64 exec, vcc
    buffer_load_dword v1, v7, s[48:51], s26 offen sc1
    s_mov_b64 exec, -1
    s_waitcnt vmcnt(0)
    v_cmp_ne_u32 vcc, s7, v1
    s_nop 0
    s_cmp_eq_u64 vcc, 0
    s_cbranch_scc1 L_poll_ok_36
    s_sleep 2
    s_sub_u32 s8, s8, 1
    s_cmp_lg_u32 s8, 0
    s_cbranch_scc1 L_poll_35
L_poll_ok_36:
L_sp_ok_33:
    s_nop 4
    s_branch L_back_31
L_slow_38:
    s_add_u32 s26, s100, 0
    s_add_u32 s24, s26, 65536
    s_add_u32 s25, s26, 131072
L_sp_40:
    s_cmp_ge_u32 s24, s25
    s_cbranch_scc1 L_sp_fb_42
    s_load_dwordx4 s[16:19], s[48:49], s24
    s_add_u32 s24, s24, 65536
    s_waitcnt lgkmcnt(0)
    s_xor_b64 s[16:17], s[16:17], s[0:1]
    s_xor_b64 s[18:19], s[18:19], s[0:1]
    s_or_b64 s[16:17], s[16:17], s[18:19]
    s_cbranch_scc0 L_sp_ok_41
    s_branch L_sp_40
L_sp_fb_42:
    s_mov_b32 s8, 0x100000
    s_mov_b64 vcc, -1
L_poll_43:
    s_mov_b64 exec, vcc
    buffer_load_dword v1, v7, s[48:51], s26 offen sc1
    s_mov_b64 exec, -1
    s_waitcnt vmcnt(0)
    v_cmp_ne_u32 vcc, s7, v1
    s_nop 0
    s_cmp_eq_u64 vcc, 0
    s_cbranch_scc1 L_poll_ok_44
    s_sleep 2
    s_sub_u32 s8, s8, 1
    s_cmp_lg_u32 s8, 0
    s_cbranch_scc1 L_poll_43
L_poll_ok_44:
L_sp_ok_41:
    s_nop 4
    s_branch L_back_39
L_slow_45:
    s_add_u32 s26, s15, 256
    s_add_u32 s24, s26, 65536
    s_add_u32 s25, s26, 131072
L_sp_47:
    s_cmp_ge_u32 s24, s25
    s_cbranch_scc1 L_sp_fb_49
    s_load_dwordx4 s[16:19], s[48:49], s24
    s_add_u32 s24, s24, 65536
    s_waitcnt lgkmcnt(0)
    s_xor_b64 s[16:17], s[16:17], s[0:1]
    s_xor_b64 s[18:19], s[18:19], s[0:1]
    s_or_b64 s[16:17], s[16:17], s[18:19]
    s_cbranch_scc0 L_sp_ok_48
    s_branch L_sp_47
L_sp_fb_49:
    s_mov_b32 s8, 0x100000
    s_mov_b64 vcc, -1
L_poll_50:
    s_mov_b64 exec, vcc
    buffer_load_dword v1, v7, s[48:51], s26 offen sc1
    s_mov_b64 exec, -1
    s_waitcnt vmcnt(0)
    v_cmp_ne_u32 vcc, s7, v1
    s_nop 0
    s_cmp_eq_u64 vcc, 0
    s_cbranch_scc1 L_poll_ok_51
    s_sleep 2
    s_sub_u32 s8, s8, 1
    s_cmp_lg_u32 s8, 0
    s_cbranch_scc1 L_poll_50
L_poll_ok_51:
L_sp_ok_48:
    s_nop 4
    s_branch L_back_46
L_slow_53:
    s_add_u32 s26, s100, 256
    s_add_u32 s24, s26, 65536
    s_add_u32 s25, s26, 131072
L_sp_55:
    s_cmp_ge_u32 s24, s25
    s_cbranch_scc1 L_sp_fb_57
    s_load_dwordx4 s[16:19], s[48:49], s24
    s_add_u32 s24, s24, 65536
    s_waitcnt lgkmcnt(0)
    s_xor_b64 s[16:17], s[16:17], s[0:1]
    s_xor_b64 s[18:19], s[18:19], s[0:1]
    s_or_b64 s[16:17], s[16:17], s[18:19]
    s_cbranch_scc0 L_sp_ok_56
    s_branch L_sp_55
L_sp_fb_57:
    s_mov_b32 s8, 0x100000
    s_mov_b64 vcc, -1
L_poll_58:
    s_mov_b64 exec, vcc
    buffer_load_dword v1, v7, s[48:51], s26 offen sc1
    s_mov_b64 exec, -1
    s_waitcnt vmcnt(0)
    v_cmp_ne_u32 vcc, s7, v1
    s_nop 0
    s_cmp_eq_u64 vcc, 0
    s_cbranch_scc1 L_poll_ok_59
    s_sleep 2
    s_sub_u32 s8, s8, 1
    s_cmp_lg_u32 s8, 0
    s_cbranch_scc1 L_poll_58
L_poll_ok_59:
L_sp_ok_56:
    s_nop 4
    s_branch L_back_54
L_slow_60:
    s_add_u32 s26, s15, 512
    s_add_u32 s24, s26, 65536
    s_add_u32 s25, s26, 131072
L_sp_62:
    s_cmp_ge_u32 s24, s25
    s_cbranch_scc1 L_sp_fb_64
    s_load_dwordx4 s[16:19], s[48:49], s24
    s_add_u32 s24, s24, 65536
    s_waitcnt lgkmcnt(0)
    s_xor_b64 s[16:17], s[16:17], s[0:1]
    s_xor_b64 s[18:19], s[18:19], s[0:1]
    s_or_b64 s[16:17], s[16:17], s[18:19]
    s_cbranch_scc0 L_sp_ok_63
    s_branch L_sp_62
L_sp_fb_64:
    s_mov_b32 s8, 0x100000
    s_mov_b64 vcc, -1
L_poll_65:
    s_mov_b64 exec, vcc
    buffer_load_dword v1, v7, s[48:51], s26 offen sc1
    s_mov_b64 exec, -1
    s_waitcnt vmcnt(0)
    v_cmp_ne_u32 vcc, s7, v1
    s_nop 0
    s_cmp_eq_u64 vcc, 0
    s_cbranch_scc1 L_poll_ok_66
    s_sleep 2
    s_sub_u32 s8, s8, 1
    s_cmp_lg_u32 s8, 0
    s_cbranch_scc1 L_poll_65
L_poll_ok_66:
L_sp_ok_63:
    s_nop 4
    s_branch L_back_61
L_slow_67:
    s_add_u32 s26, s100, 512
    s_add_u32 s24, s26, 65536
    s_add_u32 s25, s26, 131072
L_sp_69:
    s_cmp_ge_u32 s24, s25
    s_cbranch_scc1 L_sp_fb_71
    s_load_dwordx4 s[16:19], s[48:49], s24
    s_add_u32 s24, s24, 65536
    s_waitcnt lgkmcnt(0)
    s_xor_b64 s[16:17], s[16:17], s[0:1]
    s_xor_b64 s[18:19], s[18:19], s[0:1]
    s_or_b64 s[16:17], s[16:17], s[18:19]
    s_cbranch_scc0 L_sp_ok_70
    s_branch L_sp_69
L_sp_fb_71:
    s_mov_b32 s8, 0x100000
    s_mov_b64 vcc, -1
L_poll_72:
    s_mov_b64 exec, vcc
    buffer_load_dword v1, v7, s[48:51], s26 offen sc1
    s_mov_b64 exec, -1
    s_waitcnt vmcnt(0)
    v_cmp_ne_u32 vcc, s7, v1
    s_nop 0
    s_cmp_eq_u64 vcc, 0
    s_cbranch_scc1 L_poll_ok_73
    s_sleep 2
    s_sub_u32 s8, s8, 1
    s_cmp_lg_u32 s8, 0
    s_cbranch_scc1 L_poll_72
L_poll_ok_73:
L_sp_ok_70:
    s_nop 4
    s_branch L_back_68
L_slow_74:
    s_mov_b32 s8, 0x100000
    s_mov_b64 vcc, -1
L_poll_76:
    s_mov_b64 exec, vcc
    buffer_load_dwordx2 v[30:31], v11, s[48:51], s10 offen sc1
    s_mov_b64 exec, -1
    s_waitcnt vmcnt(0)
    v_cmp_ne_u32 vcc, s7, v31
    s_nop 0
    s_cmp_eq_u64 vcc, 0
    s_cbranch_scc1 L_poll_ok_77
    s_sleep 2
    s_sub_u32 s8, s8, 1
    s_cmp_lg_u32 s8, 0
    s_cbranch_scc1 L_poll_76
L_poll_ok_77:
    s_nop 4
    s_branch L_back_75
L_slow_78:
    s_waitcnt vmcnt(0)
    v_cmp_ne_u32 vcc, s7, v1
    s_nop 0
    s_cmp_eq_u64 vcc, 0
    s_cbranch_scc0 L_a2_80
    s_add_u32 m0, s9, 0
    s_nop 0
    buffer_load_dwordx4 v10, s[48:51], s42 offen sc1 lds
    s_add_u32 s67, s42, 131072
    s_add_u32 m0, s9, 1024
    s_nop 0
    buffer_load_dwordx4 v10, s[48:51], s67 offen sc1 lds
    s_lshl_b32 s67, s47, 8
    s_add_u32 s67, s67, s42
    s_add_u32 m0, s9, 2048
    s_nop 0
    buffer_load_dwordx4 v10, s[48:51], s67 offen sc1 lds
    s_mov_b32 s43, 1
L_a2_80:
    s_nop 4
    s_branch L_back_79
L_slow_81:
L_sp_83:
    s_cmp_ge_u32 s78, s79
    s_cbranch_scc1 L_sp_fb_85
    s_load_dwordx8 s[16:23], s[48:49], s78
    s_load_dwordx8 s[24:31], s[48:49], s78 offset:512
    s_add_u32 s67, s78, s47
    s_load_dwordx8 s[32:39], s[48:49], s67
    s_add_u32 s78, s78, 16384
    s_waitcnt lgkmcnt(0)
    s_xor_b64 s[16:17], s[16:17], s[0:1]
    s_xor_b64 s[18:19], s[18:19], s[0:1]
    s_xor_b64 s[20:21], s[20:21], s[0:1]
    s_xor_b64 s[22:23], s[22:23], s[0:1]
    s_xor_b64 s[24:25], s[24:25], s[0:1]
    s_xor_b64 s[26:27], s[26:27], s[0:1]
    s_xor_b64 s[28:29], s[28:29], s[0:1]
    s_xor_b64 s[30:31], s[30:31], s[0:1]
    s_xor_b64 s[32:33], s[32:33], s[0:1]
    s_xor_b64 s[34:35], s[34:35], s[0:1]
    s_xor_b64 s[36:37], s[36:37], s[0:1]
    s_xor_b64 s[38:39], s[38:39], s[0:1]
    s_or_b64 s[16:17], s[16:17], s[18:19]
    s_or_b64 s[16:17], s[16:17], s[20:21]
    s_or_b64 s[16:17], s[16:17], s[22:23]
    s_or_b64 s[16:17], s[16:17], s[24:25]
    s_or_b64 s[16:17], s[16:17], s[26:27]
    s_or_b64 s[16:17], s[16:17], s[28:29]
    s_or_b64 s[16:17], s[16:17], s[30:31]
    s_or_b64 s[16:17], s[16:17], s[32:33]
    s_or_b64 s[16:17], s[16:17], s[34:35]
    s_or_b64 s[16:17], s[16:17], s[36:37]
    s_or_b64 s[16:17], s[16:17], s[38:39]
    s_cbranch_scc0 L_sp_ok_84
    s_sleep 4
    s_branch L_sp_83
L_sp_fb_85:
    s_mov_b32 s8, 0x100000
    s_mov_b64 vcc, -1
L_poll_86:
    s_mov_b64 exec, vcc
    buffer_load_dword v1, v9, s[48:51], s4 offen sc1
    s_mov_b64 exec, -1
    s_waitcnt vmcnt(0)
    v_cmp_ne_u32 vcc, s7, v1
    s_nop 0
    s_cmp_eq_u64 vcc, 0
    s_cbranch_scc1 L_poll_ok_87
    s_sleep 2
    s_sub_u32 s8, s8, 1
    s_cmp_lg_u32 s8, 0
    s_cbranch_scc1 L_poll_86
L_poll_ok_87:
L_sp_ok_84:
    s_waitcnt vmcnt(0)
    s_add_u32 m0, s9, 0
    s_nop 0
    buffer_load_dwordx4 v10, s[48:51], s42 offen sc1 lds
    s_add_u32 s67, s42, 131072
    s_add_u32 m0, s9, 1024
    s_nop 0
    buffer_load_dwordx4 v10, s[48:51], s67 offen sc1 lds
    s_lshl_b32 s67, s47, 8
    s_add_u32 s67, s67, s42
    s_add_u32 m0, s9, 2048
    s_nop 0
    buffer_load_dwordx4 v10, s[48:51], s67 offen sc1 lds
    s_nop 4
    s_branch L_back_82
.fill ((33024 - (. - gated_mix__ssm_conv_s4__dense_activation_silu__prompt_kernel)) / 4), 4, 0xbf810000
.section .rodata,"a"
.p2align 6
.amdhsa_kernel gated_mix__ssm_conv_s4__dense_activation_silu__prompt_kernel
  .amdhsa_next_free_vgpr 256
  .amdhsa_next_free_sgpr 102
  .amdhsa_accum_offset 256
  .amdhsa_group_segment_fixed_size 0
  .amdhsa_kernarg_size 128
  .amdhsa_user_sgpr_count 2
  .amdhsa_user_sgpr_kernarg_segment_ptr 1
  .amdhsa_system_sgpr_workgroup_id_x 1
.end_amdhsa_kernel
```
